```python
import torch

def _softmax(x, axis=-1):
    return torch.softmax(x, dim=axis)
def _gelu(x):
    return torch.nn.functional.gelu(x, approximate="tanh")
def _silu(x):
    return torch.nn.functional.silu(x)
def _sigmoid(x):
    return torch.sigmoid(x)
def _layernorm(x, axis=-1, eps=1e-5):
    m = x.mean(dim=axis, keepdim=True)
    v = x.var(dim=axis, keepdim=True, unbiased=False)
    return (x - m) / torch.sqrt(v + eps)
def _scatter_add(tgt, idx, src, axis=0):
    return tgt.clone().index_add_(axis, idx, src)
def _segment_sum(src, seg, n):
    out = torch.zeros((n,) + src.shape[1:], dtype=src.dtype)
    return out.index_add_(0, seg, src)
def _pad(x, pw):
    flat = tuple(v for pair in reversed(pw) for v in pair)
    return torch.nn.functional.pad(x, flat)

kernel_name = 'concat_heads__ssm_conv_h3__sliding_block__prompt'

def setup_inputs():

    _w = (lambda a: (lambda t: t.to(torch.bfloat16) if t.is_floating_point() else t)(torch.as_tensor(a)))
    def _A_setup():
        B, S, D = 1, 2048, 640
        ks = 4
        return {
            "q": _w((lambda *s: torch.randn(*s, dtype=torch.bfloat16) * 0.05)(B, S, D)),
            "k": _w((lambda *s: torch.randn(*s, dtype=torch.bfloat16) * 0.8)(B, S, D)),
            "v": _w((lambda *s: torch.randn(*s, dtype=torch.bfloat16) * 0.8)(B, S, D)),
            "shift_k": _w((lambda *s: torch.randn(*s, dtype=torch.bfloat16) * 0.8)(D, ks) * 0.5),
            "ssm_k": _w((lambda *s: torch.randn(*s, dtype=torch.bfloat16) * 3.2)(D, S) * (1.0 / S ** 0.5)),
            "ssm_D": _w((lambda *s: torch.randn(*s, dtype=torch.bfloat16) * 0.8)(D)),
        }
    _A_in = _A_setup()

    def _B_setup():
        B, S, D = 1, 2048, 640
        return {
            "x": _w((lambda *s: torch.randn(*s, dtype=torch.bfloat16) * 0.2)(B, S, D)),
            "wqkv": _w((lambda *s: torch.randn(*s, dtype=torch.bfloat16) * 0.2)(D, 3 * D)),
            "wo": _w((lambda *s: torch.randn(*s, dtype=torch.bfloat16) * 0.05)(D, D)),
        }
    _B_in = _B_setup()

    return {
        "A_q": _A_in["q"],
        "A_k": _A_in["k"],
        "A_v": _A_in["v"],
        "A_shift_k": _A_in["shift_k"],
        "A_ssm_k": _A_in["ssm_k"],
        "A_ssm_D": _A_in["ssm_D"],
        "B_x": _B_in["x"],
        "B_wqkv": _B_in["wqkv"],
        "B_wo": _B_in["wo"],
    }

def reference(A_q, A_k, A_v, A_shift_k, A_ssm_k, A_ssm_D, B_x, B_wqkv, B_wo):
    def _A_ref(q, k, v, shift_k, ssm_k, ssm_D):
        B, S, D = q.shape
        ks = shift_k.shape[-1]
        k_pad = _pad(k, ((0, 0), (ks - 1, 0), (0, 0)))
        k_shift = torch.zeros_like(k)
        for t in range(ks):
            k_shift = k_shift + k_pad[:, t:t + S, :] * shift_k[:, ks - 1 - t][None, None, :]
        kv = k_shift * v
        L = 2 * S
        kv_pad = _pad(kv, ((0, 0), (0, S), (0, 0)))
        kf_pad = _pad(ssm_k, ((0, 0), (0, S)))
        kv_f = (lambda x, axes=(-2,-1): torch.fft.rfft2(x.float(), dim=axes))(kv_pad[:, None, :, :], axes=(1, 2))
        kf_f = (lambda x, axes=(-2,-1): torch.fft.rfft2(x.float(), dim=axes))(kf_pad[:, None, :], axes=(1, 2))
        kf_f = (lambda x, *d: x.permute(*d))(kf_f, 1, 2, 0)
        y_f = kv_f * kf_f[None, :, :, :]
        y = (lambda x, s, axes=(-2,-1): torch.fft.irfft2(x, s=s, dim=axes).to(torch.bfloat16))(y_f, (1, L), axes=(1, 2))[:, 0, :S, :]
        y = y + kv * ssm_D[None, None, :]
        return q * y

    def _B_ref(x, wqkv, wo):
        B, S, D = x.shape
        H = 32; Dh = D // H; W = 256
        qkv = (lambda x, *d: x.permute(*d))((x @ wqkv).reshape(B, S, 3, H, Dh), 2, 0, 3, 1, 4)
        q, k, v = qkv[0], qkv[1], qkv[2]
        scores = torch.einsum("bhqd,bhkd->bhqk", q, k) * (Dh ** -0.5)
        idx = torch.arange(S)
        mask = (idx[:, None] - idx[None, :] >= 0) & (idx[:, None] - idx[None, :] < W)
        scores = torch.where(mask[None, None], scores, -1e9)
        p = _softmax(scores, axis=-1)
        o = torch.einsum("bhqk,bhkd->bhqd", p, v)
        return (lambda x, *d: x.permute(*d))(o, 0, 2, 1, 3).reshape(B, S, D) @ wo

    a = _A_ref(A_q, A_k, A_v, A_shift_k, A_ssm_k, A_ssm_D)
    b = _B_ref(B_x, B_wqkv, B_wo)
    return torch.concatenate([a, b], axis=-1)
```

```asm
; @launch kernel=k1_kernel grid=(240,1,1) block=(768,1,1) lds=163840
; @launch kernel=k2_kernel grid=(936,1,1) block=(256,1,1) lds=39680
; @launch kernel=k3_kernel grid=(256,1,1) block=(512,1,1) lds=122880
.amdgcn_target "amdgcn-amd-amdhsa--gfx950"
.text
.globl k1_kernel
.p2align 8
.type k1_kernel,@function
k1_kernel:
    s_cmp_ge_u32 s2, 240
    s_cbranch_scc1 K1_EXIT
    s_load_dwordx2 s[4:5], s[0:1], 48
    s_load_dwordx2 s[6:7], s[0:1], 56
    s_load_dwordx2 s[8:9], s[0:1], 88
    s_load_dwordx2 s[10:11], s[0:1], 8
    s_load_dwordx2 s[12:13], s[0:1], 16
    s_load_dwordx2 s[14:15], s[0:1], 24
    s_load_dwordx2 s[60:61], s[0:1], 32
    s_load_dwordx2 s[62:63], s[0:1], 0
    s_load_dwordx2 s[64:65], s[0:1], 64
    v_lshrrev_b32 v1, 6, v0
    v_and_b32 v0, 63, v0
    v_readfirstlane_b32 s3, v1
    s_and_b32 s16, s2, 7
    s_mul_i32 s16, s16, 30
    s_lshr_b32 s17, s2, 3
    s_add_u32 s16, s16, s17
    s_mul_i32 s17, s16, 1093
    s_lshr_b32 s17, s17, 16
    s_mul_i32 s18, s17, 60
    s_sub_u32 s18, s16, s18
    s_lshl_b32 s17, s17, 2
    s_and_b32 s16, s18, 3
    s_add_u32 s16, s16, s17
    s_lshr_b32 s17, s18, 2
    s_waitcnt lgkmcnt(0)
    s_cmp_ge_u32 s3, 8
    s_cbranch_scc1 K1_PREP
    s_cmp_ge_u32 s3, 4
    s_cbranch_scc1 K1_HELPER
    s_mov_b32 s20, s4
    s_mov_b32 s21, s5
    s_mov_b32 s22, 0x280000
    s_mov_b32 s23, 0x20000
    s_mov_b32 s24, s6
    s_mov_b32 s25, s7
    s_mov_b32 s26, 0x258000
    s_mov_b32 s27, 0x20000
    s_lshl_b32 s18, s2, 2
    s_add_u32 s18, s18, s3
    s_lshl_b32 s18, s18, 10
    v_lshlrev_b32 v1, 4, v0
    s_add_u32 s19, s18, 0xf0000
    s_add_u32 s28, s18, 0x1e0000
    buffer_load_dwordx4 v[112:115], v1, s[20:23], s18 offen
    buffer_load_dwordx4 v[116:119], v1, s[24:27], s18 offen
    buffer_load_dwordx4 v[120:123], v1, s[20:23], s19 offen
    buffer_load_dwordx4 v[124:127], v1, s[24:27], s19 offen
    buffer_load_dwordx4 v[128:131], v1, s[20:23], s28 offen
    buffer_load_dwordx4 v[132:135], v1, s[24:27], s28 offen
    s_lshr_b32 s18, s3, 1
    s_and_b32 s19, s3, 1
    v_and_b32 v1, 31, v0
    v_lshrrev_b32 v2, 5, v0
    v_lshrrev_b32 v3, 1, v1
    v_and_b32 v3, 7, v3
    v_xor_b32 v3, v3, v2
    v_lshlrev_b32 v3, 4, v3
    s_lshl_b32 s20, s18, 6
    v_add_u32 v4, s20, v1
    v_lshlrev_b32 v4, 7, v4
    v_add_u32 v4, v4, v3
    v_xor_b32 v5, 32, v4
    v_xor_b32 v6, 64, v4
    v_xor_b32 v7, 0x60, v4
    v_lshrrev_b32 v8, 4, v0
    v_lshrrev_b32 v9, 2, v0
    v_and_b32 v9, 3, v9
    v_and_b32 v10, 3, v0
    v_lshrrev_b32 v11, 1, v8
    v_lshlrev_b32 v11, 3, v11
    v_add_u32 v11, v11, v9
    v_lshlrev_b32 v11, 8, v11
    v_and_b32 v12, 1, v8
    v_lshlrev_b32 v12, 5, v12
    v_lshlrev_b32 v10, 3, v10
    v_add3_u32 v11, v11, v12, v10
    v_add_u32 v11, 0x4000, v11
    s_lshl_b32 s20, s19, 1
    v_xor_b32 v12, s20, v9
    v_lshlrev_b32 v12, 6, v12
    v_add_u32 v8, v11, v12
    s_add_u32 s20, s20, 1
    v_xor_b32 v12, s20, v9
    v_lshlrev_b32 v12, 6, v12
    v_add_u32 v9, v11, v12
    v_mov_b32 v48, 0
    v_mov_b32 v49, 0
    v_mov_b32 v50, 0
    v_mov_b32 v51, 0
    v_mov_b32 v52, 0
    v_mov_b32 v53, 0
    v_mov_b32 v54, 0
    v_mov_b32 v55, 0
    v_mov_b32 v56, 0
    v_mov_b32 v57, 0
    v_mov_b32 v58, 0
    v_mov_b32 v59, 0
    v_mov_b32 v60, 0
    v_mov_b32 v61, 0
    v_mov_b32 v62, 0
    v_mov_b32 v63, 0
    v_mov_b32 v64, 0
    v_mov_b32 v65, 0
    v_mov_b32 v66, 0
    v_mov_b32 v67, 0
    v_mov_b32 v68, 0
    v_mov_b32 v69, 0
    v_mov_b32 v70, 0
    v_mov_b32 v71, 0
    v_mov_b32 v72, 0
    v_mov_b32 v73, 0
    v_mov_b32 v74, 0
    v_mov_b32 v75, 0
    v_mov_b32 v76, 0
    v_mov_b32 v77, 0
    v_mov_b32 v78, 0
    v_mov_b32 v79, 0
    v_mov_b32 v80, 0
    v_mov_b32 v81, 0
    v_mov_b32 v82, 0
    v_mov_b32 v83, 0
    v_mov_b32 v84, 0
    v_mov_b32 v85, 0
    v_mov_b32 v86, 0
    v_mov_b32 v87, 0
    v_mov_b32 v88, 0
    v_mov_b32 v89, 0
    v_mov_b32 v90, 0
    v_mov_b32 v91, 0
    v_mov_b32 v92, 0
    v_mov_b32 v93, 0
    v_mov_b32 v94, 0
    v_mov_b32 v95, 0
    v_mov_b32 v96, 0
    v_mov_b32 v97, 0
    v_mov_b32 v98, 0
    v_mov_b32 v99, 0
    v_mov_b32 v100, 0
    v_mov_b32 v101, 0
    v_mov_b32 v102, 0
    v_mov_b32 v103, 0
    v_mov_b32 v104, 0
    v_mov_b32 v105, 0
    v_mov_b32 v106, 0
    v_mov_b32 v107, 0
    v_mov_b32 v108, 0
    v_mov_b32 v109, 0
    v_mov_b32 v110, 0
    v_mov_b32 v111, 0
    v_mov_b32 v10, v4
    v_mov_b32 v11, v5
    v_mov_b32 v12, v6
    v_mov_b32 v13, v7
    v_mov_b32 v14, v8
    v_mov_b32 v15, v9
    s_mov_b32 s21, 0
    s_mov_b32 s22, 0
    s_barrier
    ds_read_b128 v[16:19], v10
    ds_read_b64_tr_b16 v[24:25], v14 offset:0
    ds_read_b64_tr_b16 v[26:27], v14 offset:1024
    ds_read_b64_tr_b16 v[28:29], v15 offset:0
    ds_read_b64_tr_b16 v[30:31], v15 offset:1024
    ds_read_b128 v[20:23], v10 offset:4096
K1_LOOP_G:
    s_waitcnt lgkmcnt(3)
    v_mfma_f32_32x32x16_bf16 v[48:63], v[16:19], v[24:27], v[48:63]
    ds_read_b128 v[32:35], v11
    ds_read_b64_tr_b16 v[40:41], v14 offset:4096
    s_waitcnt lgkmcnt(3)
    v_mfma_f32_32x32x16_bf16 v[64:79], v[16:19], v[28:31], v[64:79]
    ds_read_b64_tr_b16 v[42:43], v14 offset:5120
    ds_read_b64_tr_b16 v[44:45], v15 offset:4096
    s_waitcnt lgkmcnt(4)
    v_mfma_f32_32x32x16_bf16 v[80:95], v[20:23], v[24:27], v[80:95]
    ds_read_b64_tr_b16 v[46:47], v15 offset:5120
    ds_read_b128 v[36:39], v11 offset:4096
    v_mfma_f32_32x32x16_bf16 v[96:111], v[20:23], v[28:31], v[96:111]
    s_waitcnt lgkmcnt(3)
    v_mfma_f32_32x32x16_bf16 v[48:63], v[32:35], v[40:43], v[48:63]
    ds_read_b128 v[16:19], v12
    ds_read_b64_tr_b16 v[24:25], v14 offset:8192
    s_waitcnt lgkmcnt(3)
    v_mfma_f32_32x32x16_bf16 v[64:79], v[32:35], v[44:47], v[64:79]
    ds_read_b64_tr_b16 v[26:27], v14 offset:9216
    ds_read_b64_tr_b16 v[28:29], v15 offset:8192
    s_waitcnt lgkmcnt(4)
    v_mfma_f32_32x32x16_bf16 v[80:95], v[36:39], v[40:43], v[80:95]
    ds_read_b64_tr_b16 v[30:31], v15 offset:9216
    ds_read_b128 v[20:23], v12 offset:4096
    v_mfma_f32_32x32x16_bf16 v[96:111], v[36:39], v[44:47], v[96:111]
    s_waitcnt lgkmcnt(3)
    v_mfma_f32_32x32x16_bf16 v[48:63], v[16:19], v[24:27], v[48:63]
    ds_read_b128 v[32:35], v13
    ds_read_b64_tr_b16 v[40:41], v14 offset:12288
    s_waitcnt lgkmcnt(3)
    v_mfma_f32_32x32x16_bf16 v[64:79], v[16:19], v[28:31], v[64:79]
    ds_read_b64_tr_b16 v[42:43], v14 offset:13312
    ds_read_b64_tr_b16 v[44:45], v15 offset:12288
    s_waitcnt lgkmcnt(4)
    v_mfma_f32_32x32x16_bf16 v[80:95], v[20:23], v[24:27], v[80:95]
    ds_read_b64_tr_b16 v[46:47], v15 offset:13312
    ds_read_b128 v[36:39], v13 offset:4096
    v_mfma_f32_32x32x16_bf16 v[96:111], v[20:23], v[28:31], v[96:111]
    s_add_u32 s21, s21, 1
    s_add_u32 s22, s22, 0x8000
    s_cmp_eq_u32 s22, 0x28000
    s_cselect_b32 s22, 0, s22
    v_add_u32 v10, s22, v4
    v_add_u32 v11, s22, v5
    v_add_u32 v12, s22, v6
    v_add_u32 v14, s22, v8
    v_add_u32 v15, s22, v9
    v_add_u32 v13, s22, v7
    s_cmp_eq_u32 s21, 10
    s_waitcnt lgkmcnt(3)
    v_mfma_f32_32x32x16_bf16 v[48:63], v[32:35], v[40:43], v[48:63]
    s_waitcnt lgkmcnt(1)
    v_mfma_f32_32x32x16_bf16 v[64:79], v[32:35], v[44:47], v[64:79]
    s_waitcnt lgkmcnt(0)
    s_cbranch_scc1 K1_LAST_G
    s_barrier
    ds_read_b128 v[16:19], v10
    ds_read_b64_tr_b16 v[24:25], v14 offset:0
    ds_read_b64_tr_b16 v[26:27], v14 offset:1024
    v_mfma_f32_32x32x16_bf16 v[80:95], v[36:39], v[40:43], v[80:95]
    ds_read_b64_tr_b16 v[28:29], v15 offset:0
    ds_read_b64_tr_b16 v[30:31], v15 offset:1024
    ds_read_b128 v[20:23], v10 offset:4096
    v_mfma_f32_32x32x16_bf16 v[96:111], v[36:39], v[44:47], v[96:111]
    s_branch K1_LOOP_G
K1_LAST_G:
    v_mfma_f32_32x32x16_bf16 v[80:95], v[36:39], v[40:43], v[80:95]
    v_mfma_f32_32x32x16_bf16 v[96:111], v[36:39], v[44:47], v[96:111]
    s_mov_b32 s28, s8
    s_mov_b32 s29, s9
    s_mov_b32 s30, 0x780000
    s_mov_b32 s31, 0x20000
    s_cmp_ge_u32 s17, 5
    s_cselect_b32 s27, 1.0, 0x3ea52b5c
    s_lshl_b32 s23, s19, 6
    v_add_u32 v3, s23, v1
    v_mul_u32_u24 v3, 272, v3
    s_lshl_b32 s24, s18, 7
    v_add_u32 v3, s24, v3
    s_cmp_ge_u32 s17, 10
    s_cselect_b32 s25, 4, 3
    s_cselect_b32 s26, 8, 16
    v_lshlrev_b32 v4, s25, v2
    v_add_u32 v3, v3, v4
    v_add_u32 v4, s26, v3
    s_barrier
    v_mul_f32 v48, s27, v48
    v_mul_f32 v49, s27, v49
    v_mul_f32 v50, s27, v50
    v_mul_f32 v51, s27, v51
    v_cvt_pk_bf16_f32 v16, v48, v49
    v_cvt_pk_bf16_f32 v17, v50, v51
    ds_write_b64 v3, v[16:17] offset:0
    v_mul_f32 v52, s27, v52
    v_mul_f32 v53, s27, v53
    v_mul_f32 v54, s27, v54
    v_mul_f32 v55, s27, v55
    v_cvt_pk_bf16_f32 v18, v52, v53
    v_cvt_pk_bf16_f32 v19, v54, v55
    ds_write_b64 v4, v[18:19] offset:0
    v_mul_f32 v56, s27, v56
    v_mul_f32 v57, s27, v57
    v_mul_f32 v58, s27, v58
    v_mul_f32 v59, s27, v59
    v_cvt_pk_bf16_f32 v20, v56, v57
    v_cvt_pk_bf16_f32 v21, v58, v59
    ds_write_b64 v3, v[20:21] offset:32
    v_mul_f32 v60, s27, v60
    v_mul_f32 v61, s27, v61
    v_mul_f32 v62, s27, v62
    v_mul_f32 v63, s27, v63
    v_cvt_pk_bf16_f32 v22, v60, v61
    v_cvt_pk_bf16_f32 v23, v62, v63
    ds_write_b64 v4, v[22:23] offset:32
    v_mul_f32 v80, s27, v80
    v_mul_f32 v81, s27, v81
    v_mul_f32 v82, s27, v82
    v_mul_f32 v83, s27, v83
    v_cvt_pk_bf16_f32 v24, v80, v81
    v_cvt_pk_bf16_f32 v25, v82, v83
    ds_write_b64 v3, v[24:25] offset:64
    v_mul_f32 v84, s27, v84
    v_mul_f32 v85, s27, v85
    v_mul_f32 v86, s27, v86
    v_mul_f32 v87, s27, v87
    v_cvt_pk_bf16_f32 v26, v84, v85
    v_cvt_pk_bf16_f32 v27, v86, v87
    ds_write_b64 v4, v[26:27] offset:64
    v_mul_f32 v88, s27, v88
    v_mul_f32 v89, s27, v89
    v_mul_f32 v90, s27, v90
    v_mul_f32 v91, s27, v91
    v_cvt_pk_bf16_f32 v28, v88, v89
    v_cvt_pk_bf16_f32 v29, v90, v91
    ds_write_b64 v3, v[28:29] offset:96
    v_mul_f32 v92, s27, v92
    v_mul_f32 v93, s27, v93
    v_mul_f32 v94, s27, v94
    v_mul_f32 v95, s27, v95
    v_cvt_pk_bf16_f32 v30, v92, v93
    v_cvt_pk_bf16_f32 v31, v94, v95
    ds_write_b64 v4, v[30:31] offset:96
    v_mul_f32 v64, s27, v64
    v_mul_f32 v65, s27, v65
    v_mul_f32 v66, s27, v66
    v_mul_f32 v67, s27, v67
    v_cvt_pk_bf16_f32 v16, v64, v65
    v_cvt_pk_bf16_f32 v17, v66, v67
    ds_write_b64 v3, v[16:17] offset:8704
    v_mul_f32 v68, s27, v68
    v_mul_f32 v69, s27, v69
    v_mul_f32 v70, s27, v70
    v_mul_f32 v71, s27, v71
    v_cvt_pk_bf16_f32 v18, v68, v69
    v_cvt_pk_bf16_f32 v19, v70, v71
    ds_write_b64 v4, v[18:19] offset:8704
    v_mul_f32 v72, s27, v72
    v_mul_f32 v73, s27, v73
    v_mul_f32 v74, s27, v74
    v_mul_f32 v75, s27, v75
    v_cvt_pk_bf16_f32 v20, v72, v73
    v_cvt_pk_bf16_f32 v21, v74, v75
    ds_write_b64 v3, v[20:21] offset:8736
    v_mul_f32 v76, s27, v76
    v_mul_f32 v77, s27, v77
    v_mul_f32 v78, s27, v78
    v_mul_f32 v79, s27, v79
    v_cvt_pk_bf16_f32 v22, v76, v77
    v_cvt_pk_bf16_f32 v23, v78, v79
    ds_write_b64 v4, v[22:23] offset:8736
    v_mul_f32 v96, s27, v96
    v_mul_f32 v97, s27, v97
    v_mul_f32 v98, s27, v98
    v_mul_f32 v99, s27, v99
    v_cvt_pk_bf16_f32 v24, v96, v97
    v_cvt_pk_bf16_f32 v25, v98, v99
    ds_write_b64 v3, v[24:25] offset:8768
    v_mul_f32 v100, s27, v100
    v_mul_f32 v101, s27, v101
    v_mul_f32 v102, s27, v102
    v_mul_f32 v103, s27, v103
    v_cvt_pk_bf16_f32 v26, v100, v101
    v_cvt_pk_bf16_f32 v27, v102, v103
    ds_write_b64 v4, v[26:27] offset:8768
    v_mul_f32 v104, s27, v104
    v_mul_f32 v105, s27, v105
    v_mul_f32 v106, s27, v106
    v_mul_f32 v107, s27, v107
    v_cvt_pk_bf16_f32 v28, v104, v105
    v_cvt_pk_bf16_f32 v29, v106, v107
    ds_write_b64 v3, v[28:29] offset:8800
    v_mul_f32 v108, s27, v108
    v_mul_f32 v109, s27, v109
    v_mul_f32 v110, s27, v110
    v_mul_f32 v111, s27, v111
    v_cvt_pk_bf16_f32 v30, v108, v109
    v_cvt_pk_bf16_f32 v31, v110, v111
    ds_write_b64 v4, v[30:31] offset:8800
    v_lshrrev_b32 v5, 4, v0
    v_and_b32 v6, 15, v0
    s_lshl_b32 s23, s3, 5
    v_add_u32 v5, s23, v5
    v_mul_u32_u24 v7, 272, v5
    v_lshl_add_u32 v7, v6, 4, v7
    s_lshl_b32 s23, s17, 7
    v_add_u32 v5, s23, v5
    v_lshlrev_b32 v5, 12, v5
    v_lshl_add_u32 v5, v6, 4, v5
    s_lshl_b32 s24, s16, 8
    v_add_u32 v5, s24, v5
    s_waitcnt lgkmcnt(0)
    s_barrier
    ds_read_b128 v[48:51], v7 offset:0
    ds_read_b128 v[52:55], v7 offset:1088
    ds_read_b128 v[56:59], v7 offset:2176
    ds_read_b128 v[60:63], v7 offset:3264
    ds_read_b128 v[64:67], v7 offset:4352
    ds_read_b128 v[68:71], v7 offset:5440
    ds_read_b128 v[72:75], v7 offset:6528
    ds_read_b128 v[76:79], v7 offset:7616
    s_mov_b32 s23, 0
    s_waitcnt lgkmcnt(7)
    buffer_store_dwordx4 v[48:51], v5, s[28:31], s23 offen
    s_mov_b32 s23, 16384
    s_waitcnt lgkmcnt(6)
    buffer_store_dwordx4 v[52:55], v5, s[28:31], s23 offen
    s_mov_b32 s23, 32768
    s_waitcnt lgkmcnt(5)
    buffer_store_dwordx4 v[56:59], v5, s[28:31], s23 offen
    s_mov_b32 s23, 49152
    s_waitcnt lgkmcnt(4)
    buffer_store_dwordx4 v[60:63], v5, s[28:31], s23 offen
    s_mov_b32 s23, 65536
    s_waitcnt lgkmcnt(3)
    buffer_store_dwordx4 v[64:67], v5, s[28:31], s23 offen
    s_mov_b32 s23, 81920
    s_waitcnt lgkmcnt(2)
    buffer_store_dwordx4 v[68:71], v5, s[28:31], s23 offen
    s_mov_b32 s23, 98304
    s_waitcnt lgkmcnt(1)
    buffer_store_dwordx4 v[72:75], v5, s[28:31], s23 offen
    s_mov_b32 s23, 114688
    s_waitcnt lgkmcnt(0)
    buffer_store_dwordx4 v[76:79], v5, s[28:31], s23 offen
    s_branch K1_END
K1_HELPER:
    s_mov_b32 s20, s4
    s_mov_b32 s21, s5
    s_mov_b32 s22, 0x280000
    s_mov_b32 s23, 0x20000
    s_mov_b32 s24, s6
    s_mov_b32 s25, s7
    s_mov_b32 s26, 0x258000
    s_mov_b32 s27, 0x20000
    s_sub_u32 s18, s3, 4
    v_lshrrev_b32 v1, 3, v0
    v_and_b32 v2, 7, v0
    v_lshrrev_b32 v3, 4, v0
    s_lshl_b32 s19, s16, 7
    s_lshl_b32 s28, s18, 5
    s_add_u32 s19, s19, s28
    v_add_u32 v4, s19, v1
    v_mul_u32_u24 v4, 0x500, v4
    v_xor_b32 v5, v2, v3
    v_xor_b32 v6, 4, v5
    v_lshl_add_u32 v10, v5, 4, v4
    v_lshl_add_u32 v11, v6, 4, v4
    v_add_u32 v11, 0x2400, v11
    v_add_u32 v12, 0x4800, v10
    v_add_u32 v13, 0x4800, v11
    s_lshl_b32 s28, s18, 4
    v_add_u32 v4, s28, v3
    v_mul_u32_u24 v4, 0xf00, v4
    v_and_b32 v5, 15, v0
    v_lshlrev_b32 v6, 2, v3
    v_xor_b32 v5, v5, v6
    v_lshl_add_u32 v4, v5, 4, v4
    s_lshl_b32 s28, s17, 8
    v_add_u32 v14, s28, v4
    v_add_u32 v15, 0x3800, v14
    v_add_u32 v16, 0x7000, v14
    v_add_u32 v17, 0xa800, v14
    s_lshl_b32 s19, s18, 12
    s_add_u32 m0, s19, 0x0
    s_mov_b32 s29, 0
    buffer_load_dwordx4 v10, s[20:23], s29 offen offset:0 lds
    buffer_load_dwordx4 v11, s[20:23], s29 offen offset:1024 lds
    buffer_load_dwordx4 v12, s[20:23], s29 offen offset:2048 lds
    buffer_load_dwordx4 v13, s[20:23], s29 offen offset:3072 lds
    s_add_u32 m0, s19, 0x4000
    s_mov_b32 s29, 0
    buffer_load_dwordx4 v14, s[24:27], s29 offen offset:0 lds
    buffer_load_dwordx4 v15, s[24:27], s29 offen offset:1024 lds
    buffer_load_dwordx4 v16, s[24:27], s29 offen offset:2048 lds
    buffer_load_dwordx4 v17, s[24:27], s29 offen offset:3072 lds
    s_add_u32 m0, s19, 0x8000
    s_mov_b32 s29, 128
    buffer_load_dwordx4 v10, s[20:23], s29 offen offset:0 lds
    buffer_load_dwordx4 v11, s[20:23], s29 offen offset:1024 lds
    buffer_load_dwordx4 v12, s[20:23], s29 offen offset:2048 lds
    buffer_load_dwordx4 v13, s[20:23], s29 offen offset:3072 lds
    s_add_u32 m0, s19, 0xc000
    s_mov_b32 s29, 245760
    buffer_load_dwordx4 v14, s[24:27], s29 offen offset:0 lds
    buffer_load_dwordx4 v15, s[24:27], s29 offen offset:1024 lds
    buffer_load_dwordx4 v16, s[24:27], s29 offen offset:2048 lds
    buffer_load_dwordx4 v17, s[24:27], s29 offen offset:3072 lds
    s_add_u32 m0, s19, 0x10000
    s_mov_b32 s29, 256
    buffer_load_dwordx4 v10, s[20:23], s29 offen offset:0 lds
    buffer_load_dwordx4 v11, s[20:23], s29 offen offset:1024 lds
    buffer_load_dwordx4 v12, s[20:23], s29 offen offset:2048 lds
    buffer_load_dwordx4 v13, s[20:23], s29 offen offset:3072 lds
    s_add_u32 m0, s19, 0x14000
    s_mov_b32 s29, 491520
    buffer_load_dwordx4 v14, s[24:27], s29 offen offset:0 lds
    buffer_load_dwordx4 v15, s[24:27], s29 offen offset:1024 lds
    buffer_load_dwordx4 v16, s[24:27], s29 offen offset:2048 lds
    buffer_load_dwordx4 v17, s[24:27], s29 offen offset:3072 lds
    s_waitcnt vmcnt(16)
    s_barrier
    s_add_u32 m0, s19, 0x18000
    s_mov_b32 s29, 384
    buffer_load_dwordx4 v10, s[20:23], s29 offen offset:0 lds
    buffer_load_dwordx4 v11, s[20:23], s29 offen offset:1024 lds
    buffer_load_dwordx4 v12, s[20:23], s29 offen offset:2048 lds
    buffer_load_dwordx4 v13, s[20:23], s29 offen offset:3072 lds
    s_add_u32 m0, s19, 0x1c000
    s_mov_b32 s29, 737280
    buffer_load_dwordx4 v14, s[24:27], s29 offen offset:0 lds
    buffer_load_dwordx4 v15, s[24:27], s29 offen offset:1024 lds
    buffer_load_dwordx4 v16, s[24:27], s29 offen offset:2048 lds
    buffer_load_dwordx4 v17, s[24:27], s29 offen offset:3072 lds
    s_add_u32 m0, s19, 0x20000
    s_mov_b32 s29, 512
    buffer_load_dwordx4 v10, s[20:23], s29 offen offset:0 lds
    buffer_load_dwordx4 v11, s[20:23], s29 offen offset:1024 lds
    buffer_load_dwordx4 v12, s[20:23], s29 offen offset:2048 lds
    buffer_load_dwordx4 v13, s[20:23], s29 offen offset:3072 lds
    s_add_u32 m0, s19, 0x24000
    s_mov_b32 s29, 983040
    buffer_load_dwordx4 v14, s[24:27], s29 offen offset:0 lds
    buffer_load_dwordx4 v15, s[24:27], s29 offen offset:1024 lds
    buffer_load_dwordx4 v16, s[24:27], s29 offen offset:2048 lds
    buffer_load_dwordx4 v17, s[24:27], s29 offen offset:3072 lds
    s_waitcnt vmcnt(24)
    s_barrier
    s_add_u32 m0, s19, 0x0
    s_mov_b32 s29, 640
    buffer_load_dwordx4 v10, s[20:23], s29 offen offset:0 lds
    buffer_load_dwordx4 v11, s[20:23], s29 offen offset:1024 lds
    buffer_load_dwordx4 v12, s[20:23], s29 offen offset:2048 lds
    buffer_load_dwordx4 v13, s[20:23], s29 offen offset:3072 lds
    s_add_u32 m0, s19, 0x4000
    s_mov_b32 s29, 1228800
    buffer_load_dwordx4 v14, s[24:27], s29 offen offset:0 lds
    buffer_load_dwordx4 v15, s[24:27], s29 offen offset:1024 lds
    buffer_load_dwordx4 v16, s[24:27], s29 offen offset:2048 lds
    buffer_load_dwordx4 v17, s[24:27], s29 offen offset:3072 lds
    s_waitcnt vmcnt(24)
    s_barrier
    s_add_u32 m0, s19, 0x8000
    s_mov_b32 s29, 768
    buffer_load_dwordx4 v10, s[20:23], s29 offen offset:0 lds
    buffer_load_dwordx4 v11, s[20:23], s29 offen offset:1024 lds
    buffer_load_dwordx4 v12, s[20:23], s29 offen offset:2048 lds
    buffer_load_dwordx4 v13, s[20:23], s29 offen offset:3072 lds
    s_add_u32 m0, s19, 0xc000
    s_mov_b32 s29, 1474560
    buffer_load_dwordx4 v14, s[24:27], s29 offen offset:0 lds
    buffer_load_dwordx4 v15, s[24:27], s29 offen offset:1024 lds
    buffer_load_dwordx4 v16, s[24:27], s29 offen offset:2048 lds
    buffer_load_dwordx4 v17, s[24:27], s29 offen offset:3072 lds
    s_waitcnt vmcnt(24)
    s_barrier
    s_add_u32 m0, s19, 0x10000
    s_mov_b32 s29, 896
    buffer_load_dwordx4 v10, s[20:23], s29 offen offset:0 lds
    buffer_load_dwordx4 v11, s[20:23], s29 offen offset:1024 lds
    buffer_load_dwordx4 v12, s[20:23], s29 offen offset:2048 lds
    buffer_load_dwordx4 v13, s[20:23], s29 offen offset:3072 lds
    s_add_u32 m0, s19, 0x14000
    s_mov_b32 s29, 1720320
    buffer_load_dwordx4 v14, s[24:27], s29 offen offset:0 lds
    buffer_load_dwordx4 v15, s[24:27], s29 offen offset:1024 lds
    buffer_load_dwordx4 v16, s[24:27], s29 offen offset:2048 lds
    buffer_load_dwordx4 v17, s[24:27], s29 offen offset:3072 lds
    s_waitcnt vmcnt(24)
    s_barrier
    s_add_u32 m0, s19, 0x18000
    s_mov_b32 s29, 1024
    buffer_load_dwordx4 v10, s[20:23], s29 offen offset:0 lds
    buffer_load_dwordx4 v11, s[20:23], s29 offen offset:1024 lds
    buffer_load_dwordx4 v12, s[20:23], s29 offen offset:2048 lds
    buffer_load_dwordx4 v13, s[20:23], s29 offen offset:3072 lds
    s_add_u32 m0, s19, 0x1c000
    s_mov_b32 s29, 1966080
    buffer_load_dwordx4 v14, s[24:27], s29 offen offset:0 lds
    buffer_load_dwordx4 v15, s[24:27], s29 offen offset:1024 lds
    buffer_load_dwordx4 v16, s[24:27], s29 offen offset:2048 lds
    buffer_load_dwordx4 v17, s[24:27], s29 offen offset:3072 lds
    s_waitcnt vmcnt(24)
    s_barrier
    s_add_u32 m0, s19, 0x20000
    s_mov_b32 s29, 1152
    buffer_load_dwordx4 v10, s[20:23], s29 offen offset:0 lds
    buffer_load_dwordx4 v11, s[20:23], s29 offen offset:1024 lds
    buffer_load_dwordx4 v12, s[20:23], s29 offen offset:2048 lds
    buffer_load_dwordx4 v13, s[20:23], s29 offen offset:3072 lds
    s_add_u32 m0, s19, 0x24000
    s_mov_b32 s29, 2211840
    buffer_load_dwordx4 v14, s[24:27], s29 offen offset:0 lds
    buffer_load_dwordx4 v15, s[24:27], s29 offen offset:1024 lds
    buffer_load_dwordx4 v16, s[24:27], s29 offen offset:2048 lds
    buffer_load_dwordx4 v17, s[24:27], s29 offen offset:3072 lds
    s_waitcnt vmcnt(24)
    s_barrier
    s_waitcnt vmcnt(16)
    s_barrier
    s_waitcnt vmcnt(8)
    s_barrier
    s_waitcnt vmcnt(0)
    s_barrier
    s_branch K1_END
K1_PREP:
    s_mov_b32 s68, s60
    s_mov_b32 s69, s61
    s_mov_b32 s70, 0x280000
    s_mov_b32 s71, 0x20000
    s_mov_b32 s72, s62
    s_mov_b32 s73, s63
    s_mov_b32 s74, 0x280000
    s_mov_b32 s75, 0x20000
    s_sub_u32 s18, s3, 8
    v_lshlrev_b32 v18, 4, v0
    s_lshl_b32 s57, s2, 2
    s_add_u32 s57, s57, s18
    s_lshl_b32 s57, s57, 10
    s_add_u32 s58, s57, 0xf0000
    s_add_u32 s59, s57, 0x1e0000
    s_mul_i32 s28, s2, 3
    s_add_u32 s28, s28, s18
    s_cmp_eq_u32 s18, 3
    s_cbranch_scc1 K1_P_NONE
    s_cmp_ge_u32 s28, 640
    s_cbranch_scc1 K1_P_NONE
    s_mov_b32 s32, s10
    s_mov_b32 s33, s11
    s_mov_b32 s34, 0x280000
    s_mov_b32 s35, 0x20000
    s_mov_b32 s36, s12
    s_mov_b32 s37, s13
    s_mov_b32 s38, 0x280000
    s_mov_b32 s39, 0x20000
    s_mov_b32 s40, s14
    s_mov_b32 s41, s15
    s_mov_b32 s42, 0x1400
    s_mov_b32 s43, 0x20000
    s_add_u32 s44, s8, 0xa00000
    s_addc_u32 s45, s9, 0
    s_mov_b32 s46, 0x500000
    s_mov_b32 s47, 0x20000
    s_mul_i32 s30, s28, 6554
    s_lshr_b32 s30, s30, 16
    s_mul_i32 s31, s30, 10
    s_sub_u32 s31, s28, s31
    s_lshl_b32 s30, s30, 5
    s_lshl_b32 s31, s31, 6
    v_and_b32 v20, 31, v0
    v_lshlrev_b32 v20, 1, v20
    v_add_u32 v20, s31, v20
    v_lshrrev_b32 v21, 5, v0
    v_lshlrev_b32 v21, 4, v21
    v_add_u32 v21, s30, v21
    v_mul_u32_u24 v22, 0x500, v21
    v_lshl_add_u32 v22, v20, 1, v22
    v_subrev_u32 v23, 0x1400, v22
    v_lshlrev_b32 v24, 3, v20
    v_lshlrev_b32 v25, 12, v20
    v_lshlrev_b32 v21, 1, v21
    v_sub_u32 v25, v25, v21
    v_add_u32 v25, 0xfe0, v25
    s_mov_b32 s50, 5120
    s_mov_b32 s51, 10240
    s_mov_b32 s52, 15360
    s_mov_b32 s53, 4096
    s_mov_b32 s54, 0x280000
    s_mov_b32 s55, 0x281000
    s_mov_b32 s56, 0xffff0000
    s_barrier
    s_barrier
    s_barrier
    s_barrier
    s_barrier
    s_barrier
    s_barrier
    buffer_load_dwordx4 v[72:75], v24, s[40:43], 0 offen
    buffer_load_dword v33, v23, s[32:35], 0 offen offset:1280
    buffer_load_dword v34, v23, s[32:35], 0 offen offset:2560
    buffer_load_dword v35, v23, s[32:35], 0 offen offset:3840
    buffer_load_dword v36, v22, s[32:35], 0 offen offset:0
    buffer_load_dword v53, v22, s[36:39], 0 offen offset:0
    buffer_load_dword v37, v22, s[32:35], 0 offen offset:1280
    buffer_load_dword v54, v22, s[36:39], 0 offen offset:1280
    buffer_load_dword v38, v22, s[32:35], 0 offen offset:2560
    buffer_load_dword v55, v22, s[36:39], 0 offen offset:2560
    buffer_load_dword v39, v22, s[32:35], 0 offen offset:3840
    buffer_load_dword v56, v22, s[36:39], 0 offen offset:3840
    buffer_load_dword v40, v22, s[32:35], s50 offen offset:0
    buffer_load_dword v57, v22, s[36:39], s50 offen offset:0
    buffer_load_dword v41, v22, s[32:35], s50 offen offset:1280
    buffer_load_dword v58, v22, s[36:39], s50 offen offset:1280
    buffer_load_dword v42, v22, s[32:35], s50 offen offset:2560
    buffer_load_dword v59, v22, s[36:39], s50 offen offset:2560
    buffer_load_dword v43, v22, s[32:35], s50 offen offset:3840
    buffer_load_dword v60, v22, s[36:39], s50 offen offset:3840
    buffer_load_dword v44, v22, s[32:35], s51 offen offset:0
    buffer_load_dword v61, v22, s[36:39], s51 offen offset:0
    buffer_load_dword v45, v22, s[32:35], s51 offen offset:1280
    buffer_load_dword v62, v22, s[36:39], s51 offen offset:1280
    buffer_load_dword v46, v22, s[32:35], s51 offen offset:2560
    buffer_load_dword v63, v22, s[36:39], s51 offen offset:2560
    buffer_load_dword v47, v22, s[32:35], s51 offen offset:3840
    buffer_load_dword v64, v22, s[36:39], s51 offen offset:3840
    buffer_load_dword v48, v22, s[32:35], s52 offen offset:0
    buffer_load_dword v65, v22, s[36:39], s52 offen offset:0
    buffer_load_dword v49, v22, s[32:35], s52 offen offset:1280
    buffer_load_dword v66, v22, s[36:39], s52 offen offset:1280
    buffer_load_dword v50, v22, s[32:35], s52 offen offset:2560
    buffer_load_dword v67, v22, s[36:39], s52 offen offset:2560
    buffer_load_dword v51, v22, s[32:35], s52 offen offset:3840
    buffer_load_dword v68, v22, s[36:39], s52 offen offset:3840
    s_barrier
    s_barrier
    s_barrier
    s_waitcnt vmcnt(0)
    v_lshlrev_b32 v76, 16, v72
    v_and_b32 v77, s56, v72
    v_lshlrev_b32 v78, 16, v73
    v_and_b32 v79, s56, v73
    v_lshlrev_b32 v80, 16, v74
    v_and_b32 v81, s56, v74
    v_lshlrev_b32 v82, 16, v75
    v_and_b32 v83, s56, v75
    v_lshlrev_b32 v85, 16, v33
    v_and_b32 v89, s56, v33
    v_lshlrev_b32 v86, 16, v34
    v_and_b32 v90, s56, v34
    v_lshlrev_b32 v87, 16, v35
    v_and_b32 v91, s56, v35
    v_lshlrev_b32 v84, 16, v36
    v_and_b32 v88, s56, v36
    v_mul_f32 v93, v84, v76
    v_fmac_f32 v93, v87, v77
    v_fmac_f32 v93, v86, v78
    v_fmac_f32 v93, v85, v79
    v_mul_f32 v111, v88, v80
    v_fmac_f32 v111, v91, v81
    v_fmac_f32 v111, v90, v82
    v_fmac_f32 v111, v89, v83
    v_lshlrev_b32 v26, 16, v53
    v_and_b32 v27, s56, v53
    v_mul_f32 v93, v93, v26
    v_mul_f32 v111, v111, v27
    v_lshlrev_b32 v85, 16, v37
    v_and_b32 v89, s56, v37
    v_mul_f32 v94, v85, v76
    v_fmac_f32 v94, v84, v77
    v_fmac_f32 v94, v87, v78
    v_fmac_f32 v94, v86, v79
    v_mul_f32 v112, v89, v80
    v_fmac_f32 v112, v88, v81
    v_fmac_f32 v112, v91, v82
    v_fmac_f32 v112, v90, v83
    v_lshlrev_b32 v26, 16, v54
    v_and_b32 v27, s56, v54
    v_mul_f32 v94, v94, v26
    v_mul_f32 v112, v112, v27
    v_lshlrev_b32 v86, 16, v38
    v_and_b32 v90, s56, v38
    v_mul_f32 v95, v86, v76
    v_fmac_f32 v95, v85, v77
    v_fmac_f32 v95, v84, v78
    v_fmac_f32 v95, v87, v79
    v_mul_f32 v113, v90, v80
    v_fmac_f32 v113, v89, v81
    v_fmac_f32 v113, v88, v82
    v_fmac_f32 v113, v91, v83
    v_lshlrev_b32 v26, 16, v55
    v_and_b32 v27, s56, v55
    v_mul_f32 v95, v95, v26
    v_mul_f32 v113, v113, v27
    v_lshlrev_b32 v87, 16, v39
    v_and_b32 v91, s56, v39
    v_mul_f32 v96, v87, v76
    v_fmac_f32 v96, v86, v77
    v_fmac_f32 v96, v85, v78
    v_fmac_f32 v96, v84, v79
    v_mul_f32 v114, v91, v80
    v_fmac_f32 v114, v90, v81
    v_fmac_f32 v114, v89, v82
    v_fmac_f32 v114, v88, v83
    v_lshlrev_b32 v26, 16, v56
    v_and_b32 v27, s56, v56
    v_mul_f32 v96, v96, v26
    v_mul_f32 v114, v114, v27
    v_lshlrev_b32 v84, 16, v40
    v_and_b32 v88, s56, v40
    v_mul_f32 v97, v84, v76
    v_fmac_f32 v97, v87, v77
    v_fmac_f32 v97, v86, v78
    v_fmac_f32 v97, v85, v79
    v_mul_f32 v115, v88, v80
    v_fmac_f32 v115, v91, v81
    v_fmac_f32 v115, v90, v82
    v_fmac_f32 v115, v89, v83
    v_lshlrev_b32 v26, 16, v57
    v_and_b32 v27, s56, v57
    v_mul_f32 v97, v97, v26
    v_mul_f32 v115, v115, v27
    v_lshlrev_b32 v85, 16, v41
    v_and_b32 v89, s56, v41
    s_barrier
    v_mul_f32 v98, v85, v76
    v_fmac_f32 v98, v84, v77
    v_fmac_f32 v98, v87, v78
    v_fmac_f32 v98, v86, v79
    v_mul_f32 v116, v89, v80
    v_fmac_f32 v116, v88, v81
    v_fmac_f32 v116, v91, v82
    v_fmac_f32 v116, v90, v83
    v_lshlrev_b32 v26, 16, v58
    v_and_b32 v27, s56, v58
    v_mul_f32 v98, v98, v26
    v_mul_f32 v116, v116, v27
    v_lshlrev_b32 v86, 16, v42
    v_and_b32 v90, s56, v42
    v_mul_f32 v99, v86, v76
    v_fmac_f32 v99, v85, v77
    v_fmac_f32 v99, v84, v78
    v_fmac_f32 v99, v87, v79
    v_mul_f32 v117, v90, v80
    v_fmac_f32 v117, v89, v81
    v_fmac_f32 v117, v88, v82
    v_fmac_f32 v117, v91, v83
    v_lshlrev_b32 v26, 16, v59
    v_and_b32 v27, s56, v59
    v_mul_f32 v99, v99, v26
    v_mul_f32 v117, v117, v27
    v_lshlrev_b32 v87, 16, v43
    v_and_b32 v91, s56, v43
    v_mul_f32 v100, v87, v76
    v_fmac_f32 v100, v86, v77
    v_fmac_f32 v100, v85, v78
    v_fmac_f32 v100, v84, v79
    v_mul_f32 v118, v91, v80
    v_fmac_f32 v118, v90, v81
    v_fmac_f32 v118, v89, v82
    v_fmac_f32 v118, v88, v83
    v_lshlrev_b32 v26, 16, v60
    v_and_b32 v27, s56, v60
    v_mul_f32 v100, v100, v26
    v_mul_f32 v118, v118, v27
    v_lshlrev_b32 v84, 16, v44
    v_and_b32 v88, s56, v44
    v_mul_f32 v101, v84, v76
    v_fmac_f32 v101, v87, v77
    v_fmac_f32 v101, v86, v78
    v_fmac_f32 v101, v85, v79
    v_mul_f32 v119, v88, v80
    v_fmac_f32 v119, v91, v81
    v_fmac_f32 v119, v90, v82
    v_fmac_f32 v119, v89, v83
    v_lshlrev_b32 v26, 16, v61
    v_and_b32 v27, s56, v61
    v_mul_f32 v101, v101, v26
    v_mul_f32 v119, v119, v27
    v_lshlrev_b32 v85, 16, v45
    v_and_b32 v89, s56, v45
    v_mul_f32 v102, v85, v76
    v_fmac_f32 v102, v84, v77
    v_fmac_f32 v102, v87, v78
    v_fmac_f32 v102, v86, v79
    v_mul_f32 v120, v89, v80
    v_fmac_f32 v120, v88, v81
    v_fmac_f32 v120, v91, v82
    v_fmac_f32 v120, v90, v83
    v_lshlrev_b32 v26, 16, v62
    v_and_b32 v27, s56, v62
    v_mul_f32 v102, v102, v26
    v_mul_f32 v120, v120, v27
    v_lshlrev_b32 v86, 16, v46
    v_and_b32 v90, s56, v46
    v_mul_f32 v103, v86, v76
    v_fmac_f32 v103, v85, v77
    v_fmac_f32 v103, v84, v78
    v_fmac_f32 v103, v87, v79
    v_mul_f32 v121, v90, v80
    v_fmac_f32 v121, v89, v81
    v_fmac_f32 v121, v88, v82
    v_fmac_f32 v121, v91, v83
    v_lshlrev_b32 v26, 16, v63
    v_and_b32 v27, s56, v63
    v_mul_f32 v103, v103, v26
    v_mul_f32 v121, v121, v27
    v_lshlrev_b32 v87, 16, v47
    v_and_b32 v91, s56, v47
    v_mul_f32 v104, v87, v76
    v_fmac_f32 v104, v86, v77
    s_barrier
    v_fmac_f32 v104, v85, v78
    v_fmac_f32 v104, v84, v79
    v_mul_f32 v122, v91, v80
    v_fmac_f32 v122, v90, v81
    v_fmac_f32 v122, v89, v82
    v_fmac_f32 v122, v88, v83
    v_lshlrev_b32 v26, 16, v64
    v_and_b32 v27, s56, v64
    v_mul_f32 v104, v104, v26
    v_mul_f32 v122, v122, v27
    v_lshlrev_b32 v84, 16, v48
    v_and_b32 v88, s56, v48
    v_mul_f32 v105, v84, v76
    v_fmac_f32 v105, v87, v77
    v_fmac_f32 v105, v86, v78
    v_fmac_f32 v105, v85, v79
    v_mul_f32 v123, v88, v80
    v_fmac_f32 v123, v91, v81
    v_fmac_f32 v123, v90, v82
    v_fmac_f32 v123, v89, v83
    v_lshlrev_b32 v26, 16, v65
    v_and_b32 v27, s56, v65
    v_mul_f32 v105, v105, v26
    v_mul_f32 v123, v123, v27
    v_lshlrev_b32 v85, 16, v49
    v_and_b32 v89, s56, v49
    v_mul_f32 v106, v85, v76
    v_fmac_f32 v106, v84, v77
    v_fmac_f32 v106, v87, v78
    v_fmac_f32 v106, v86, v79
    v_mul_f32 v124, v89, v80
    v_fmac_f32 v124, v88, v81
    v_fmac_f32 v124, v91, v82
    v_fmac_f32 v124, v90, v83
    v_lshlrev_b32 v26, 16, v66
    v_and_b32 v27, s56, v66
    v_mul_f32 v106, v106, v26
    v_mul_f32 v124, v124, v27
    v_lshlrev_b32 v86, 16, v50
    v_and_b32 v90, s56, v50
    v_mul_f32 v107, v86, v76
    v_fmac_f32 v107, v85, v77
    v_fmac_f32 v107, v84, v78
    v_fmac_f32 v107, v87, v79
    v_mul_f32 v125, v90, v80
    v_fmac_f32 v125, v89, v81
    v_fmac_f32 v125, v88, v82
    v_fmac_f32 v125, v91, v83
    v_lshlrev_b32 v26, 16, v67
    v_and_b32 v27, s56, v67
    v_mul_f32 v107, v107, v26
    v_mul_f32 v125, v125, v27
    v_lshlrev_b32 v87, 16, v51
    v_and_b32 v91, s56, v51
    v_mul_f32 v108, v87, v76
    v_fmac_f32 v108, v86, v77
    v_fmac_f32 v108, v85, v78
    v_fmac_f32 v108, v84, v79
    v_mul_f32 v126, v91, v80
    v_fmac_f32 v126, v90, v81
    v_fmac_f32 v126, v89, v82
    v_fmac_f32 v126, v88, v83
    v_lshlrev_b32 v26, 16, v68
    v_and_b32 v27, s56, v68
    v_mul_f32 v108, v108, v26
    v_mul_f32 v126, v126, v27
    v_cvt_pk_bf16_f32 v136, v108, v107
    v_cvt_pk_bf16_f32 v137, v106, v105
    v_cvt_pk_bf16_f32 v138, v104, v103
    v_cvt_pk_bf16_f32 v139, v102, v101
    v_cvt_pk_bf16_f32 v140, v100, v99
    v_cvt_pk_bf16_f32 v141, v98, v97
    v_cvt_pk_bf16_f32 v142, v96, v95
    v_cvt_pk_bf16_f32 v143, v94, v93
    buffer_store_dwordx4 v[136:139], v25, s[44:47], s54 offen offset:0
    buffer_store_dwordx4 v[140:143], v25, s[44:47], s54 offen offset:16
    v_cvt_pk_bf16_f32 v152, v126, v125
    v_cvt_pk_bf16_f32 v153, v124, v123
    v_cvt_pk_bf16_f32 v154, v122, v121
    v_cvt_pk_bf16_f32 v155, v120, v119
    v_cvt_pk_bf16_f32 v156, v118, v117
    v_cvt_pk_bf16_f32 v157, v116, v115
    v_cvt_pk_bf16_f32 v158, v114, v113
    v_cvt_pk_bf16_f32 v159, v112, v111
    buffer_store_dwordx4 v[152:155], v25, s[44:47], s55 offen offset:0
    buffer_store_dwordx4 v[156:159], v25, s[44:47], s55 offen offset:16
    s_branch K1_END
K1_P_NONE:
    s_barrier
    s_barrier
    s_barrier
    s_barrier
    s_barrier
    s_barrier
    s_barrier
    s_barrier
    s_barrier
    s_barrier
K1_END:
K1_EXIT:
    s_endpgm
.globl k2_kernel
.p2align 8
.type k2_kernel,@function
k2_kernel:
    s_cmp_ge_u32 s2, 936
    s_cbranch_scc1 K2_EXIT
    s_load_dwordx2 s[4:5], s[0:1], 88
    s_load_dwordx2 s[6:7], s[0:1], 32
    s_load_dwordx2 s[8:9], s[0:1], 40
    s_load_dwordx2 s[10:11], s[0:1], 64
    s_load_dwordx2 s[12:13], s[0:1], 0
    v_lshrrev_b32 v1, 6, v0
    v_and_b32 v0, 63, v0
    v_readfirstlane_b32 s3, v1
    s_cmp_ge_u32 s2, 896
    s_cbranch_scc1 K2_AUX
    s_cmp_ge_u32 s2, 768
    s_cbranch_scc1 K2_CONV1
    s_cmp_ge_u32 s2, 512
    s_cbranch_scc1 K2_CONV2
    s_setprio 2
    s_mov_b32 s17, s2
    s_and_b32 s16, s17, 31
    s_lshr_b32 s17, s17, 5
    s_lshl_b32 s18, s17, 7
    s_sub_u32 s19, s18, 256
    s_waitcnt lgkmcnt(0)
    s_mov_b32 s20, s4
    s_mov_b32 s21, s5
    s_mov_b32 s22, 0x780000
    s_mov_b32 s23, 0x20000
    s_add_u32 s32, s4, 0x780000
    s_addc_u32 s33, s5, 0
    s_mov_b32 s34, 0x280000
    s_mov_b32 s35, 0x20000
    s_mul_i32 s36, s16, 81920
    v_lshl_add_u32 v3, v0, 3, s19
    v_max_i32 v3, 0, v3
    v_lshlrev_b32 v3, 1, v3
    v_lshl_add_u32 v4, v0, 3, s18
    v_lshlrev_b32 v4, 1, v4
    s_mul_i32 s37, s3, 20480
    s_add_u32 s36, s36, s37
    s_mul_i32 s38, s3, 4160
    s_mul_i32 s39, s3, 3920
    s_mul_i32 s40, s3, 1600
    s_mov_b32 exec_hi, 0xffff
    s_add_u32 m0, s38, 0
    s_add_u32 s41, s36, 0x280000
    buffer_load_dwordx4 v3, s[20:23], s41 offen lds
    s_add_u32 m0, s38, 832
    s_add_u32 s41, s36, 0x281000
    buffer_load_dwordx4 v3, s[20:23], s41 offen lds
    s_add_u32 m0, s38, 1664
    s_add_u32 s41, s36, 0x282000
    buffer_load_dwordx4 v3, s[20:23], s41 offen lds
    s_add_u32 m0, s38, 2496
    s_add_u32 s41, s36, 0x283000
    buffer_load_dwordx4 v3, s[20:23], s41 offen lds
    s_add_u32 m0, s38, 3328
    s_add_u32 s41, s36, 0x284000
    buffer_load_dwordx4 v3, s[20:23], s41 offen lds
    s_mov_b64 exec, 0xffff
    s_add_u32 m0, s40, 33280
    s_add_u32 s41, s36, 0x0
    buffer_load_dwordx4 v4, s[20:23], s41 offen lds
    s_add_u32 m0, s40, 33600
    s_add_u32 s41, s36, 0x1000
    buffer_load_dwordx4 v4, s[20:23], s41 offen lds
    s_add_u32 m0, s40, 33920
    s_add_u32 s41, s36, 0x2000
    buffer_load_dwordx4 v4, s[20:23], s41 offen lds
    s_add_u32 m0, s40, 34240
    s_add_u32 s41, s36, 0x3000
    buffer_load_dwordx4 v4, s[20:23], s41 offen lds
    s_add_u32 m0, s40, 34560
    s_add_u32 s41, s36, 0x4000
    buffer_load_dwordx4 v4, s[20:23], s41 offen lds
    s_mov_b32 exec_lo, -1
    s_mov_b32 exec_hi, 0xffff
    s_add_u32 m0, s39, 16640
    s_add_u32 s41, s36, 0x500000
    buffer_load_dwordx4 v3, s[20:23], s41 offen lds
    s_add_u32 m0, s39, 17424
    s_add_u32 s41, s36, 0x501000
    buffer_load_dwordx4 v3, s[20:23], s41 offen lds
    s_add_u32 m0, s39, 18208
    s_add_u32 s41, s36, 0x502000
    buffer_load_dwordx4 v3, s[20:23], s41 offen lds
    s_add_u32 m0, s39, 18992
    s_add_u32 s41, s36, 0x503000
    buffer_load_dwordx4 v3, s[20:23], s41 offen lds
    s_add_u32 m0, s39, 19776
    s_add_u32 s41, s36, 0x504000
    buffer_load_dwordx4 v3, s[20:23], s41 offen lds
    s_mov_b64 exec, -1
    v_mov_b32 v8, 0x3f803f80
    v_mov_b32 v9, v8
    v_mov_b32 v10, v8
    v_mov_b32 v11, v8
    v_min_u32 v3, 55, v0
    v_lshlrev_b32 v3, 4, v3
    ds_write_b128 v3, v[8:11] offset:32320
    v_and_b32 v1, 31, v0
    v_lshrrev_b32 v2, 5, v0
    s_lshl_b32 s37, s3, 5
    s_add_u32 s38, s18, s37
    v_mov_b32 v22, 0
    v_mov_b32 v23, 0
    v_mov_b32 v30, 0
    v_mov_b32 v31, 0
    v_mov_b32 v38, 0
    v_mov_b32 v39, 0
    v_lshrrev_b32 v3, 2, v0
    v_and_b32 v3, 3, v3
    v_and_b32 v4, 3, v0
    v_lshlrev_b32 v4, 3, v4
    v_and_b32 v5, 16, v0
    v_lshl_add_u32 v4, v5, 1, v4
    s_lshl_b32 s39, s3, 6
    v_add_u32 v4, s39, v4
    v_lshl_add_u32 v5, v2, 3, v3
    v_mul_u32_u24 v6, 832, v5
    v_add_u32 v6, v6, v4
    v_mul_u32_u24 v7, 832, v3
    v_add_u32 v7, v7, v4
    v_add_u32 v7, 13312, v7
    v_mul_u32_u24 v12, 320, v5
    v_add_u32 v12, v12, v4
    v_add_u32 v12, 33280, v12
    v_mul_u32_u24 v13, 320, v3
    v_add_u32 v13, v13, v4
    v_add_u32 v13, 38400, v13
    v_mul_u32_u24 v8, 784, v1
    v_add_u32 v8, 16640, v8
    v_mov_b32 v9, 32320
    v_mov_b32 v10, 32448
    v_cmp_le_u32 vcc, 28, v1
    s_nop 1
    v_cndmask_b32 v9, v9, v10, vcc
    v_cmp_le_u32 vcc, 20, v1
    s_nop 1
    v_cndmask_b32 v8, v8, v9, vcc
    v_lshlrev_b32 v9, 4, v2
    v_add3_u32 v8, v8, v9, s39
    v_lshlrev_b32 v9, 2, v2
    v_sub_u32 v9, v1, v9
    v_cmp_le_i32 s[40:41], 0, v9
    v_cmp_le_i32 s[42:43], 1, v9
    v_cmp_le_i32 s[44:45], 2, v9
    v_cmp_le_i32 s[46:47], 3, v9
    v_cmp_le_i32 s[48:49], 8, v9
    v_cmp_le_i32 s[50:51], 9, v9
    v_cmp_le_i32 s[52:53], 10, v9
    v_cmp_le_i32 s[54:55], 11, v9
    v_cmp_le_i32 s[56:57], 16, v9
    v_cmp_le_i32 s[58:59], 17, v9
    v_cmp_le_i32 s[60:61], 18, v9
    v_cmp_le_i32 s[62:63], 19, v9
    v_cmp_le_i32 s[64:65], 24, v9
    v_cmp_le_i32 s[66:67], 25, v9
    v_cmp_le_i32 s[68:69], 26, v9
    v_cmp_le_i32 s[70:71], 27, v9
    v_mov_b32 v104, 0
    v_mov_b32 v105, 0
    v_mov_b32 v106, 0
    v_mov_b32 v107, 0
    v_mov_b32 v108, 0
    v_mov_b32 v109, 0
    v_mov_b32 v110, 0
    v_mov_b32 v111, 0
    v_mov_b32 v112, 0
    v_mov_b32 v113, 0
    v_mov_b32 v114, 0
    v_mov_b32 v115, 0
    v_mov_b32 v116, 0
    v_mov_b32 v117, 0
    v_mov_b32 v118, 0
    v_mov_b32 v119, 0
    v_mov_b32 v10, 0xff800000
    v_mov_b32 v11, 0xf149f2ca
    s_lshr_b32 s39, s38, 5
    s_sub_u32 s39, 8, s39
    s_waitcnt vmcnt(0) lgkmcnt(0)
    s_barrier
    ds_read_b64_tr_b16 v[16:17], v12
    ds_read_b64_tr_b16 v[18:19], v12 offset:1280
    ds_read_b64_tr_b16 v[20:21], v13
    ds_read_b64_tr_b16 v[24:25], v6 offset:0
    ds_read_b64_tr_b16 v[26:27], v6 offset:3328
    ds_read_b64_tr_b16 v[28:29], v7 offset:0
    ds_read_b64_tr_b16 v[32:33], v6 offset:512
    ds_read_b64_tr_b16 v[34:35], v6 offset:3840
    ds_read_b64_tr_b16 v[36:37], v7 offset:512
    v_cmp_eq_u32 vcc, 0, v2
    s_waitcnt lgkmcnt(6)
    s_nop 0
    v_cndmask_b32 v20, 0, v20, vcc
    v_cndmask_b32 v21, 0, v21, vcc
    s_waitcnt lgkmcnt(3)
    v_mfma_f32_32x32x16_bf16 v[40:55], v[24:27], v[16:19], 0
    v_mfma_f32_32x32x16_bf16 v[40:55], v[28:31], v[20:23], v[40:55]
    s_waitcnt lgkmcnt(0)
    v_mfma_f32_32x32x16_bf16 v[56:71], v[32:35], v[16:19], 0
    v_mfma_f32_32x32x16_bf16 v[56:71], v[36:39], v[20:23], v[56:71]
    ds_read_b64_tr_b16 v[24:25], v6 offset:64
    ds_read_b64_tr_b16 v[26:27], v6 offset:3392
    ds_read_b64_tr_b16 v[28:29], v7 offset:64
    ds_read_b64_tr_b16 v[32:33], v6 offset:128
    ds_read_b64_tr_b16 v[34:35], v6 offset:3456
    ds_read_b64_tr_b16 v[36:37], v7 offset:128
    s_cmp_le_i32 s39, 0
    s_cbranch_scc1 K2A_NOFIX0
    s_nop 7
    s_nop 7
    v_mov_b32 v40, v10
    v_mov_b32 v41, v10
    v_mov_b32 v42, v10
    v_mov_b32 v43, v10
    v_mov_b32 v44, v10
    v_mov_b32 v45, v10
    v_mov_b32 v46, v10
    v_mov_b32 v47, v10
    v_mov_b32 v48, v10
    v_mov_b32 v49, v10
    v_mov_b32 v50, v10
    v_mov_b32 v51, v10
    v_mov_b32 v52, v10
    v_mov_b32 v53, v10
    v_mov_b32 v54, v10
    v_mov_b32 v55, v10
K2A_NOFIX0:
    s_nop 7
    s_nop 3
    s_mov_b64 vcc, s[40:41]
    v_cndmask_b32 v40, v40, v56, vcc
    s_mov_b64 vcc, s[42:43]
    v_cndmask_b32 v41, v41, v57, vcc
    s_mov_b64 vcc, s[44:45]
    v_cndmask_b32 v42, v42, v58, vcc
    s_mov_b64 vcc, s[46:47]
    v_cndmask_b32 v43, v43, v59, vcc
    s_mov_b64 vcc, s[48:49]
    v_cndmask_b32 v44, v44, v60, vcc
    s_mov_b64 vcc, s[50:51]
    v_cndmask_b32 v45, v45, v61, vcc
    s_mov_b64 vcc, s[52:53]
    v_cndmask_b32 v46, v46, v62, vcc
    s_mov_b64 vcc, s[54:55]
    v_cndmask_b32 v47, v47, v63, vcc
    s_mov_b64 vcc, s[56:57]
    v_cndmask_b32 v48, v48, v64, vcc
    s_mov_b64 vcc, s[58:59]
    v_cndmask_b32 v49, v49, v65, vcc
    s_mov_b64 vcc, s[60:61]
    v_cndmask_b32 v50, v50, v66, vcc
    s_mov_b64 vcc, s[62:63]
    v_cndmask_b32 v51, v51, v67, vcc
    s_mov_b64 vcc, s[64:65]
    v_cndmask_b32 v52, v52, v68, vcc
    s_mov_b64 vcc, s[66:67]
    v_cndmask_b32 v53, v53, v69, vcc
    s_mov_b64 vcc, s[68:69]
    v_cndmask_b32 v54, v54, v70, vcc
    s_mov_b64 vcc, s[70:71]
    v_cndmask_b32 v55, v55, v71, vcc
    s_waitcnt lgkmcnt(3)
    v_mfma_f32_32x32x16_bf16 v[56:71], v[24:27], v[16:19], 0
    v_mfma_f32_32x32x16_bf16 v[56:71], v[28:31], v[20:23], v[56:71]
    s_waitcnt lgkmcnt(0)
    v_mfma_f32_32x32x16_bf16 v[72:87], v[32:35], v[16:19], 0
    v_mfma_f32_32x32x16_bf16 v[72:87], v[36:39], v[20:23], v[72:87]
    ds_read_b64_tr_b16 v[24:25], v6 offset:192
    ds_read_b64_tr_b16 v[26:27], v6 offset:3520
    ds_read_b64_tr_b16 v[28:29], v7 offset:192
    ds_read_b128 v[120:123], v8 offset:64
    ds_read_b128 v[124:127], v8 offset:96
    s_cmp_le_i32 s39, 1
    s_cbranch_scc1 K2A_NOFIX1
    s_nop 7
    s_nop 7
    v_mov_b32 v56, v10
    v_mov_b32 v57, v10
    v_mov_b32 v58, v10
    v_mov_b32 v59, v10
    v_mov_b32 v60, v10
    v_mov_b32 v61, v10
    v_mov_b32 v62, v10
    v_mov_b32 v63, v10
    v_mov_b32 v64, v10
    v_mov_b32 v65, v10
    v_mov_b32 v66, v10
    v_mov_b32 v67, v10
    v_mov_b32 v68, v10
    v_mov_b32 v69, v10
    v_mov_b32 v70, v10
    v_mov_b32 v71, v10
K2A_NOFIX1:
    s_nop 7
    s_nop 3
    v_max3_f32 v12, v40, v41, v11
    v_max3_f32 v13, v42, v43, v44
    v_max3_f32 v12, v12, v45, v46
    v_max3_f32 v13, v13, v47, v48
    v_max3_f32 v12, v12, v49, v50
    v_max3_f32 v13, v13, v51, v52
    v_max3_f32 v12, v12, v53, v54
    v_max3_f32 v13, v13, v55, v56
    v_max3_f32 v12, v12, v57, v58
    v_max3_f32 v13, v13, v59, v60
    v_max3_f32 v12, v12, v61, v62
    v_max3_f32 v13, v13, v63, v64
    v_max3_f32 v12, v12, v65, v66
    v_max3_f32 v13, v13, v67, v68
    v_max3_f32 v12, v12, v69, v70
    v_max3_f32 v12, v12, v13, v71
    v_mov_b32 v13, v12
    s_nop 1
    v_permlane32_swap_b32 v12, v13
    v_max_f32 v12, v12, v13
    v_mov_b32 v11, v12
    s_waitcnt lgkmcnt(2)
    v_mfma_f32_32x32x16_bf16 v[88:103], v[24:27], v[16:19], 0
    v_mfma_f32_32x32x16_bf16 v[88:103], v[28:31], v[20:23], v[88:103]
    ds_read_b64_tr_b16 v[24:25], v6 offset:256
    ds_read_b64_tr_b16 v[26:27], v6 offset:3584
    ds_read_b64_tr_b16 v[28:29], v7 offset:256
    ds_read_b64_tr_b16 v[32:33], v6 offset:320
    ds_read_b64_tr_b16 v[34:35], v6 offset:3648
    ds_read_b64_tr_b16 v[36:37], v7 offset:320
    v_sub_f32 v56, v56, v11
    v_sub_f32 v57, v57, v11
    v_sub_f32 v58, v58, v11
    v_sub_f32 v59, v59, v11
    v_sub_f32 v60, v60, v11
    v_sub_f32 v61, v61, v11
    v_sub_f32 v62, v62, v11
    v_sub_f32 v63, v63, v11
    v_sub_f32 v64, v64, v11
    v_sub_f32 v65, v65, v11
    v_sub_f32 v66, v66, v11
    v_sub_f32 v67, v67, v11
    v_sub_f32 v68, v68, v11
    v_sub_f32 v69, v69, v11
    v_sub_f32 v70, v70, v11
    v_sub_f32 v71, v71, v11
    v_exp_f32 v56, v56
    v_exp_f32 v57, v57
    v_exp_f32 v58, v58
    v_exp_f32 v59, v59
    v_exp_f32 v60, v60
    v_exp_f32 v61, v61
    v_exp_f32 v62, v62
    v_exp_f32 v63, v63
    v_exp_f32 v64, v64
    v_exp_f32 v65, v65
    v_exp_f32 v66, v66
    v_exp_f32 v67, v67
    v_exp_f32 v68, v68
    v_exp_f32 v69, v69
    v_exp_f32 v70, v70
    v_exp_f32 v71, v71
    v_cvt_pk_bf16_f32 v56, v56, v57
    v_cvt_pk_bf16_f32 v57, v58, v59
    v_cvt_pk_bf16_f32 v58, v60, v61
    v_cvt_pk_bf16_f32 v59, v62, v63
    v_cvt_pk_bf16_f32 v60, v64, v65
    v_cvt_pk_bf16_f32 v61, v66, v67
    v_cvt_pk_bf16_f32 v62, v68, v69
    v_cvt_pk_bf16_f32 v63, v70, v71
    s_waitcnt lgkmcnt(6)
    v_mfma_f32_32x32x16_bf16 v[104:119], v[120:123], v[56:59], v[104:119]
    v_mfma_f32_32x32x16_bf16 v[104:119], v[124:127], v[60:63], v[104:119]
    ds_read_b128 v[120:123], v8 offset:0
    ds_read_b128 v[124:127], v8 offset:32
    v_sub_f32 v40, v40, v11
    v_sub_f32 v41, v41, v11
    v_sub_f32 v42, v42, v11
    v_sub_f32 v43, v43, v11
    v_sub_f32 v44, v44, v11
    v_sub_f32 v45, v45, v11
    v_sub_f32 v46, v46, v11
    v_sub_f32 v47, v47, v11
    v_sub_f32 v48, v48, v11
    v_sub_f32 v49, v49, v11
    v_sub_f32 v50, v50, v11
    v_sub_f32 v51, v51, v11
    v_sub_f32 v52, v52, v11
    v_sub_f32 v53, v53, v11
    v_sub_f32 v54, v54, v11
    v_sub_f32 v55, v55, v11
    v_exp_f32 v40, v40
    v_exp_f32 v41, v41
    v_exp_f32 v42, v42
    v_exp_f32 v43, v43
    v_exp_f32 v44, v44
    v_exp_f32 v45, v45
    v_exp_f32 v46, v46
    v_exp_f32 v47, v47
    v_exp_f32 v48, v48
    v_exp_f32 v49, v49
    v_exp_f32 v50, v50
    v_exp_f32 v51, v51
    v_exp_f32 v52, v52
    v_exp_f32 v53, v53
    v_exp_f32 v54, v54
    v_exp_f32 v55, v55
    v_mov_b32 v15, 0
    s_mov_b64 vcc, s[40:41]
    v_cndmask_b32 v3, 0, v40, vcc
    v_cndmask_b32 v5, v40, v15, vcc
    s_mov_b64 vcc, s[42:43]
    v_cndmask_b32 v4, 0, v41, vcc
    v_cndmask_b32 v9, v41, v15, vcc
    v_cvt_pk_bf16_f32 v64, v3, v4
    v_cvt_pk_bf16_f32 v40, v5, v9
    s_mov_b64 vcc, s[44:45]
    v_cndmask_b32 v3, 0, v42, vcc
    v_cndmask_b32 v5, v42, v15, vcc
    s_mov_b64 vcc, s[46:47]
    v_cndmask_b32 v4, 0, v43, vcc
    v_cndmask_b32 v9, v43, v15, vcc
    v_cvt_pk_bf16_f32 v65, v3, v4
    v_cvt_pk_bf16_f32 v41, v5, v9
    s_mov_b64 vcc, s[48:49]
    v_cndmask_b32 v3, 0, v44, vcc
    v_cndmask_b32 v5, v44, v15, vcc
    s_mov_b64 vcc, s[50:51]
    v_cndmask_b32 v4, 0, v45, vcc
    v_cndmask_b32 v9, v45, v15, vcc
    v_cvt_pk_bf16_f32 v66, v3, v4
    v_cvt_pk_bf16_f32 v42, v5, v9
    s_mov_b64 vcc, s[52:53]
    v_cndmask_b32 v3, 0, v46, vcc
    v_cndmask_b32 v5, v46, v15, vcc
    s_mov_b64 vcc, s[54:55]
    v_cndmask_b32 v4, 0, v47, vcc
    v_cndmask_b32 v9, v47, v15, vcc
    v_cvt_pk_bf16_f32 v67, v3, v4
    v_cvt_pk_bf16_f32 v43, v5, v9
    s_mov_b64 vcc, s[56:57]
    v_cndmask_b32 v3, 0, v48, vcc
    v_cndmask_b32 v5, v48, v15, vcc
    s_mov_b64 vcc, s[58:59]
    v_cndmask_b32 v4, 0, v49, vcc
    v_cndmask_b32 v9, v49, v15, vcc
    v_cvt_pk_bf16_f32 v68, v3, v4
    v_cvt_pk_bf16_f32 v44, v5, v9
    s_mov_b64 vcc, s[60:61]
    v_cndmask_b32 v3, 0, v50, vcc
    v_cndmask_b32 v5, v50, v15, vcc
    s_mov_b64 vcc, s[62:63]
    v_cndmask_b32 v4, 0, v51, vcc
    v_cndmask_b32 v9, v51, v15, vcc
    v_cvt_pk_bf16_f32 v69, v3, v4
    v_cvt_pk_bf16_f32 v45, v5, v9
    s_mov_b64 vcc, s[64:65]
    v_cndmask_b32 v3, 0, v52, vcc
    v_cndmask_b32 v5, v52, v15, vcc
    s_mov_b64 vcc, s[66:67]
    v_cndmask_b32 v4, 0, v53, vcc
    v_cndmask_b32 v9, v53, v15, vcc
    v_cvt_pk_bf16_f32 v70, v3, v4
    v_cvt_pk_bf16_f32 v46, v5, v9
    s_mov_b64 vcc, s[68:69]
    v_cndmask_b32 v3, 0, v54, vcc
    v_cndmask_b32 v5, v54, v15, vcc
    s_mov_b64 vcc, s[70:71]
    v_cndmask_b32 v4, 0, v55, vcc
    v_cndmask_b32 v9, v55, v15, vcc
    v_cvt_pk_bf16_f32 v71, v3, v4
    v_cvt_pk_bf16_f32 v47, v5, v9
    s_waitcnt lgkmcnt(0)
    v_mfma_f32_32x32x16_bf16 v[104:119], v[120:123], v[40:43], v[104:119]
    v_mfma_f32_32x32x16_bf16 v[104:119], v[124:127], v[44:47], v[104:119]
    ds_read_b128 v[120:123], v8 offset:512
    ds_read_b128 v[124:127], v8 offset:544
    s_cmp_le_i32 s39, 2
    s_cbranch_scc1 K2A_NOFIX2
    s_nop 7
    s_nop 7
    v_mov_b32 v72, v10
    v_mov_b32 v73, v10
    v_mov_b32 v74, v10
    v_mov_b32 v75, v10
    v_mov_b32 v76, v10
    v_mov_b32 v77, v10
    v_mov_b32 v78, v10
    v_mov_b32 v79, v10
    v_mov_b32 v80, v10
    v_mov_b32 v81, v10
    v_mov_b32 v82, v10
    v_mov_b32 v83, v10
    v_mov_b32 v84, v10
    v_mov_b32 v85, v10
    v_mov_b32 v86, v10
    v_mov_b32 v87, v10
    s_cmp_le_i32 s39, 3
    s_cbranch_scc1 K2A_NOFIX2
    v_mov_b32 v88, v10
    v_mov_b32 v89, v10
    v_mov_b32 v90, v10
    v_mov_b32 v91, v10
    v_mov_b32 v92, v10
    v_mov_b32 v93, v10
    v_mov_b32 v94, v10
    v_mov_b32 v95, v10
    v_mov_b32 v96, v10
    v_mov_b32 v97, v10
    v_mov_b32 v98, v10
    v_mov_b32 v99, v10
    v_mov_b32 v100, v10
    v_mov_b32 v101, v10
    v_mov_b32 v102, v10
    v_mov_b32 v103, v10
K2A_NOFIX2:
    s_nop 7
    s_nop 3
    s_waitcnt lgkmcnt(0)
    v_mfma_f32_32x32x16_bf16 v[104:119], v[120:123], v[64:67], v[104:119]
    v_mfma_f32_32x32x16_bf16 v[104:119], v[124:127], v[68:71], v[104:119]
    ds_read_b128 v[120:123], v8 offset:128
    ds_read_b128 v[124:127], v8 offset:160
    v_max3_f32 v12, v72, v73, v11
    v_max3_f32 v13, v74, v75, v76
    v_max3_f32 v12, v12, v77, v78
    v_max3_f32 v13, v13, v79, v80
    v_max3_f32 v12, v12, v81, v82
    v_max3_f32 v13, v13, v83, v84
    v_max3_f32 v12, v12, v85, v86
    v_max3_f32 v13, v13, v87, v88
    v_max3_f32 v12, v12, v89, v90
    v_max3_f32 v13, v13, v91, v92
    v_max3_f32 v12, v12, v93, v94
    v_max3_f32 v13, v13, v95, v96
    v_max3_f32 v12, v12, v97, v98
    v_max3_f32 v13, v13, v99, v100
    v_max3_f32 v12, v12, v101, v102
    v_max3_f32 v12, v12, v13, v103
    v_mov_b32 v13, v12
    s_nop 1
    v_permlane32_swap_b32 v12, v13
    v_max_f32 v12, v12, v13
    v_sub_f32 v14, v11, v12
    v_exp_f32 v14, v14
    v_mov_b32 v11, v12
    v_mul_f32 v104, v104, v14
    v_mul_f32 v105, v105, v14
    v_mul_f32 v106, v106, v14
    v_mul_f32 v107, v107, v14
    v_mul_f32 v108, v108, v14
    v_mul_f32 v109, v109, v14
    v_mul_f32 v110, v110, v14
    v_mul_f32 v111, v111, v14
    v_mul_f32 v112, v112, v14
    v_mul_f32 v113, v113, v14
    v_mul_f32 v114, v114, v14
    v_mul_f32 v115, v115, v14
    v_mul_f32 v116, v116, v14
    v_mfma_f32_32x32x16_bf16 v[40:55], v[24:27], v[16:19], 0
    v_mfma_f32_32x32x16_bf16 v[40:55], v[28:31], v[20:23], v[40:55]
    v_mfma_f32_32x32x16_bf16 v[56:71], v[32:35], v[16:19], 0
    v_mfma_f32_32x32x16_bf16 v[56:71], v[36:39], v[20:23], v[56:71]
    ds_read_b64_tr_b16 v[24:25], v6 offset:384
    ds_read_b64_tr_b16 v[26:27], v6 offset:3712
    ds_read_b64_tr_b16 v[28:29], v7 offset:384
    ds_read_b64_tr_b16 v[32:33], v6 offset:448
    ds_read_b64_tr_b16 v[34:35], v6 offset:3776
    ds_read_b64_tr_b16 v[36:37], v7 offset:448
    v_sub_f32 v72, v72, v11
    v_sub_f32 v73, v73, v11
    v_sub_f32 v74, v74, v11
    v_sub_f32 v75, v75, v11
    v_sub_f32 v76, v76, v11
    v_sub_f32 v77, v77, v11
    v_sub_f32 v78, v78, v11
    v_sub_f32 v79, v79, v11
    v_sub_f32 v80, v80, v11
    v_sub_f32 v81, v81, v11
    v_sub_f32 v82, v82, v11
    v_sub_f32 v83, v83, v11
    v_sub_f32 v84, v84, v11
    v_sub_f32 v85, v85, v11
    v_sub_f32 v86, v86, v11
    v_sub_f32 v87, v87, v11
    v_exp_f32 v72, v72
    v_exp_f32 v73, v73
    v_exp_f32 v74, v74
    v_exp_f32 v75, v75
    v_exp_f32 v76, v76
    v_exp_f32 v77, v77
    v_exp_f32 v78, v78
    v_exp_f32 v79, v79
    v_exp_f32 v80, v80
    v_exp_f32 v81, v81
    v_exp_f32 v82, v82
    v_exp_f32 v83, v83
    v_exp_f32 v84, v84
    v_exp_f32 v85, v85
    v_exp_f32 v86, v86
    v_exp_f32 v87, v87
    v_cvt_pk_bf16_f32 v72, v72, v73
    v_cvt_pk_bf16_f32 v73, v74, v75
    v_cvt_pk_bf16_f32 v74, v76, v77
    v_cvt_pk_bf16_f32 v75, v78, v79
    v_cvt_pk_bf16_f32 v76, v80, v81
    v_cvt_pk_bf16_f32 v77, v82, v83
    v_cvt_pk_bf16_f32 v78, v84, v85
    v_cvt_pk_bf16_f32 v79, v86, v87
    s_waitcnt lgkmcnt(6)
    v_mfma_f32_32x32x16_bf16 v[104:119], v[120:123], v[72:75], v[104:119]
    v_mfma_f32_32x32x16_bf16 v[104:119], v[124:127], v[76:79], v[104:119]
    ds_read_b128 v[120:123], v8 offset:192
    ds_read_b128 v[124:127], v8 offset:224
    v_sub_f32 v88, v88, v11
    v_sub_f32 v89, v89, v11
    v_sub_f32 v90, v90, v11
    v_sub_f32 v91, v91, v11
    v_sub_f32 v92, v92, v11
    v_sub_f32 v93, v93, v11
    v_sub_f32 v94, v94, v11
    v_sub_f32 v95, v95, v11
    v_sub_f32 v96, v96, v11
    v_sub_f32 v97, v97, v11
    v_sub_f32 v98, v98, v11
    v_sub_f32 v99, v99, v11
    v_sub_f32 v100, v100, v11
    v_sub_f32 v101, v101, v11
    v_sub_f32 v102, v102, v11
    v_sub_f32 v103, v103, v11
    v_exp_f32 v88, v88
    v_exp_f32 v89, v89
    v_exp_f32 v90, v90
    v_exp_f32 v91, v91
    v_exp_f32 v92, v92
    v_exp_f32 v93, v93
    v_exp_f32 v94, v94
    v_exp_f32 v95, v95
    v_exp_f32 v96, v96
    v_exp_f32 v97, v97
    v_exp_f32 v98, v98
    v_exp_f32 v99, v99
    v_exp_f32 v100, v100
    v_exp_f32 v101, v101
    v_exp_f32 v102, v102
    v_exp_f32 v103, v103
    v_cvt_pk_bf16_f32 v88, v88, v89
    v_cvt_pk_bf16_f32 v89, v90, v91
    v_cvt_pk_bf16_f32 v90, v92, v93
    v_cvt_pk_bf16_f32 v91, v94, v95
    v_cvt_pk_bf16_f32 v92, v96, v97
    v_cvt_pk_bf16_f32 v93, v98, v99
    v_cvt_pk_bf16_f32 v94, v100, v101
    v_cvt_pk_bf16_f32 v95, v102, v103
    s_waitcnt lgkmcnt(0)
    v_mfma_f32_32x32x16_bf16 v[104:119], v[120:123], v[88:91], v[104:119]
    v_mfma_f32_32x32x16_bf16 v[104:119], v[124:127], v[92:95], v[104:119]
    ds_read_b128 v[120:123], v8 offset:256
    ds_read_b128 v[124:127], v8 offset:288
    s_cmp_le_i32 s39, 4
    s_cbranch_scc1 K2A_NOFIX3
    s_nop 7
    s_nop 7
    v_mov_b32 v40, v10
    v_mov_b32 v41, v10
    v_mov_b32 v42, v10
    v_mov_b32 v43, v10
    v_mov_b32 v44, v10
    v_mov_b32 v45, v10
    v_mov_b32 v46, v10
    v_mov_b32 v47, v10
    v_mov_b32 v48, v10
    v_mov_b32 v49, v10
    v_mov_b32 v50, v10
    v_mov_b32 v51, v10
    v_mov_b32 v52, v10
    v_mov_b32 v53, v10
    v_mov_b32 v54, v10
    v_mov_b32 v55, v10
    s_cmp_le_i32 s39, 5
    s_cbranch_scc1 K2A_NOFIX3
    v_mov_b32 v56, v10
    v_mov_b32 v57, v10
    v_mov_b32 v58, v10
    v_mov_b32 v59, v10
    v_mov_b32 v60, v10
    v_mov_b32 v61, v10
    v_mov_b32 v62, v10
    v_mov_b32 v63, v10
    v_mov_b32 v64, v10
    v_mov_b32 v65, v10
    v_mov_b32 v66, v10
    v_mov_b32 v67, v10
    v_mov_b32 v68, v10
    v_mov_b32 v69, v10
    v_mov_b32 v70, v10
    v_mov_b32 v71, v10
K2A_NOFIX3:
    s_nop 7
    s_nop 3
    v_max3_f32 v12, v40, v41, v11
    v_max3_f32 v13, v42, v43, v44
    v_max3_f32 v12, v12, v45, v46
    v_max3_f32 v13, v13, v47, v48
    v_max3_f32 v12, v12, v49, v50
    v_max3_f32 v13, v13, v51, v52
    v_max3_f32 v12, v12, v53, v54
    v_max3_f32 v13, v13, v55, v56
    v_max3_f32 v12, v12, v57, v58
    v_max3_f32 v13, v13, v59, v60
    v_max3_f32 v12, v12, v61, v62
    v_max3_f32 v13, v13, v63, v64
    v_max3_f32 v12, v12, v65, v66
    v_max3_f32 v13, v13, v67, v68
    v_max3_f32 v12, v12, v69, v70
    v_max3_f32 v12, v12, v13, v71
    v_mov_b32 v13, v12
    s_nop 1
    v_permlane32_swap_b32 v12, v13
    v_max_f32 v12, v12, v13
    v_sub_f32 v14, v11, v12
    v_exp_f32 v14, v14
    v_mov_b32 v11, v12
    v_mul_f32 v104, v104, v14
    v_mul_f32 v105, v105, v14
    v_mul_f32 v106, v106, v14
    v_mul_f32 v107, v107, v14
    v_mul_f32 v108, v108, v14
    v_mul_f32 v109, v109, v14
    v_mul_f32 v110, v110, v14
    v_mul_f32 v111, v111, v14
    v_mul_f32 v112, v112, v14
    v_mul_f32 v113, v113, v14
    v_mul_f32 v114, v114, v14
    v_mul_f32 v115, v115, v14
    v_mul_f32 v116, v116, v14
    v_mfma_f32_32x32x16_bf16 v[72:87], v[24:27], v[16:19], 0
    v_mfma_f32_32x32x16_bf16 v[72:87], v[28:31], v[20:23], v[72:87]
    v_mfma_f32_32x32x16_bf16 v[88:103], v[32:35], v[16:19], 0
    v_mfma_f32_32x32x16_bf16 v[88:103], v[36:39], v[20:23], v[88:103]
    v_sub_f32 v40, v40, v11
    v_sub_f32 v41, v41, v11
    v_sub_f32 v42, v42, v11
    v_sub_f32 v43, v43, v11
    v_sub_f32 v44, v44, v11
    v_sub_f32 v45, v45, v11
    v_sub_f32 v46, v46, v11
    v_sub_f32 v47, v47, v11
    v_sub_f32 v48, v48, v11
    v_sub_f32 v49, v49, v11
    v_sub_f32 v50, v50, v11
    v_sub_f32 v51, v51, v11
    v_sub_f32 v52, v52, v11
    v_sub_f32 v53, v53, v11
    v_sub_f32 v54, v54, v11
    v_sub_f32 v55, v55, v11
    v_exp_f32 v40, v40
    v_exp_f32 v41, v41
    v_exp_f32 v42, v42
    v_exp_f32 v43, v43
    v_exp_f32 v44, v44
    v_exp_f32 v45, v45
    v_exp_f32 v46, v46
    v_exp_f32 v47, v47
    v_exp_f32 v48, v48
    v_exp_f32 v49, v49
    v_exp_f32 v50, v50
    v_exp_f32 v51, v51
    v_exp_f32 v52, v52
    v_exp_f32 v53, v53
    v_exp_f32 v54, v54
    v_exp_f32 v55, v55
    v_cvt_pk_bf16_f32 v40, v40, v41
    v_cvt_pk_bf16_f32 v41, v42, v43
    v_cvt_pk_bf16_f32 v42, v44, v45
    v_cvt_pk_bf16_f32 v43, v46, v47
    v_cvt_pk_bf16_f32 v44, v48, v49
    v_cvt_pk_bf16_f32 v45, v50, v51
    v_cvt_pk_bf16_f32 v46, v52, v53
    v_cvt_pk_bf16_f32 v47, v54, v55
    s_waitcnt lgkmcnt(0)
    v_mfma_f32_32x32x16_bf16 v[104:119], v[120:123], v[40:43], v[104:119]
    v_mfma_f32_32x32x16_bf16 v[104:119], v[124:127], v[44:47], v[104:119]
    ds_read_b128 v[120:123], v8 offset:320
    ds_read_b128 v[124:127], v8 offset:352
    v_sub_f32 v56, v56, v11
    v_sub_f32 v57, v57, v11
    v_sub_f32 v58, v58, v11
    v_sub_f32 v59, v59, v11
    v_sub_f32 v60, v60, v11
    v_sub_f32 v61, v61, v11
    v_sub_f32 v62, v62, v11
    v_sub_f32 v63, v63, v11
    v_sub_f32 v64, v64, v11
    v_sub_f32 v65, v65, v11
    v_sub_f32 v66, v66, v11
    v_sub_f32 v67, v67, v11
    v_sub_f32 v68, v68, v11
    v_sub_f32 v69, v69, v11
    v_sub_f32 v70, v70, v11
    v_sub_f32 v71, v71, v11
    v_exp_f32 v56, v56
    v_exp_f32 v57, v57
    v_exp_f32 v58, v58
    v_exp_f32 v59, v59
    v_exp_f32 v60, v60
    v_exp_f32 v61, v61
    v_exp_f32 v62, v62
    v_exp_f32 v63, v63
    v_exp_f32 v64, v64
    v_exp_f32 v65, v65
    v_exp_f32 v66, v66
    v_exp_f32 v67, v67
    v_exp_f32 v68, v68
    v_exp_f32 v69, v69
    v_exp_f32 v70, v70
    v_exp_f32 v71, v71
    v_cvt_pk_bf16_f32 v56, v56, v57
    v_cvt_pk_bf16_f32 v57, v58, v59
    v_cvt_pk_bf16_f32 v58, v60, v61
    v_cvt_pk_bf16_f32 v59, v62, v63
    v_cvt_pk_bf16_f32 v60, v64, v65
    v_cvt_pk_bf16_f32 v61, v66, v67
    v_cvt_pk_bf16_f32 v62, v68, v69
    v_cvt_pk_bf16_f32 v63, v70, v71
    s_waitcnt lgkmcnt(0)
    v_mfma_f32_32x32x16_bf16 v[104:119], v[120:123], v[56:59], v[104:119]
    v_mfma_f32_32x32x16_bf16 v[104:119], v[124:127], v[60:63], v[104:119]
    ds_read_b128 v[120:123], v8 offset:384
    ds_read_b128 v[124:127], v8 offset:416
    s_cmp_le_i32 s39, 6
    s_cbranch_scc1 K2A_NOFIX4
    s_nop 7
    s_nop 7
    v_mov_b32 v72, v10
    v_mov_b32 v73, v10
    v_mov_b32 v74, v10
    v_mov_b32 v75, v10
    v_mov_b32 v76, v10
    v_mov_b32 v77, v10
    v_mov_b32 v78, v10
    v_mov_b32 v79, v10
    v_mov_b32 v80, v10
    v_mov_b32 v81, v10
    v_mov_b32 v82, v10
    v_mov_b32 v83, v10
    v_mov_b32 v84, v10
    v_mov_b32 v85, v10
    v_mov_b32 v86, v10
    v_mov_b32 v87, v10
    s_cmp_le_i32 s39, 7
    s_cbranch_scc1 K2A_NOFIX4
    v_mov_b32 v88, v10
    v_mov_b32 v89, v10
    v_mov_b32 v90, v10
    v_mov_b32 v91, v10
    v_mov_b32 v92, v10
    v_mov_b32 v93, v10
    v_mov_b32 v94, v10
    v_mov_b32 v95, v10
    v_mov_b32 v96, v10
    v_mov_b32 v97, v10
    v_mov_b32 v98, v10
    v_mov_b32 v99, v10
    v_mov_b32 v100, v10
    v_mov_b32 v101, v10
    v_mov_b32 v102, v10
    v_mov_b32 v103, v10
K2A_NOFIX4:
    s_nop 7
    s_nop 3
    v_max3_f32 v12, v72, v73, v11
    v_max3_f32 v13, v74, v75, v76
    v_max3_f32 v12, v12, v77, v78
    v_max3_f32 v13, v13, v79, v80
    v_max3_f32 v12, v12, v81, v82
    v_max3_f32 v13, v13, v83, v84
    v_max3_f32 v12, v12, v85, v86
    v_max3_f32 v13, v13, v87, v88
    v_max3_f32 v12, v12, v89, v90
    v_max3_f32 v13, v13, v91, v92
    v_max3_f32 v12, v12, v93, v94
    v_max3_f32 v13, v13, v95, v96
    v_max3_f32 v12, v12, v97, v98
    v_max3_f32 v13, v13, v99, v100
    v_max3_f32 v12, v12, v101, v102
    v_max3_f32 v12, v12, v13, v103
    v_mov_b32 v13, v12
    s_nop 1
    v_permlane32_swap_b32 v12, v13
    v_max_f32 v12, v12, v13
    v_sub_f32 v14, v11, v12
    v_exp_f32 v14, v14
    v_mov_b32 v11, v12
    v_mul_f32 v104, v104, v14
    v_mul_f32 v105, v105, v14
    v_mul_f32 v106, v106, v14
    v_mul_f32 v107, v107, v14
    v_mul_f32 v108, v108, v14
    v_mul_f32 v109, v109, v14
    v_mul_f32 v110, v110, v14
    v_mul_f32 v111, v111, v14
    v_mul_f32 v112, v112, v14
    v_mul_f32 v113, v113, v14
    v_mul_f32 v114, v114, v14
    v_mul_f32 v115, v115, v14
    v_mul_f32 v116, v116, v14
    v_sub_f32 v72, v72, v11
    v_sub_f32 v73, v73, v11
    v_sub_f32 v74, v74, v11
    v_sub_f32 v75, v75, v11
    v_sub_f32 v76, v76, v11
    v_sub_f32 v77, v77, v11
    v_sub_f32 v78, v78, v11
    v_sub_f32 v79, v79, v11
    v_sub_f32 v80, v80, v11
    v_sub_f32 v81, v81, v11
    v_sub_f32 v82, v82, v11
    v_sub_f32 v83, v83, v11
    v_sub_f32 v84, v84, v11
    v_sub_f32 v85, v85, v11
    v_sub_f32 v86, v86, v11
    v_sub_f32 v87, v87, v11
    v_exp_f32 v72, v72
    v_exp_f32 v73, v73
    v_exp_f32 v74, v74
    v_exp_f32 v75, v75
    v_exp_f32 v76, v76
    v_exp_f32 v77, v77
    v_exp_f32 v78, v78
    v_exp_f32 v79, v79
    v_exp_f32 v80, v80
    v_exp_f32 v81, v81
    v_exp_f32 v82, v82
    v_exp_f32 v83, v83
    v_exp_f32 v84, v84
    v_exp_f32 v85, v85
    v_exp_f32 v86, v86
    v_exp_f32 v87, v87
    v_cvt_pk_bf16_f32 v72, v72, v73
    v_cvt_pk_bf16_f32 v73, v74, v75
    v_cvt_pk_bf16_f32 v74, v76, v77
    v_cvt_pk_bf16_f32 v75, v78, v79
    v_cvt_pk_bf16_f32 v76, v80, v81
    v_cvt_pk_bf16_f32 v77, v82, v83
    v_cvt_pk_bf16_f32 v78, v84, v85
    v_cvt_pk_bf16_f32 v79, v86, v87
    s_waitcnt lgkmcnt(0)
    v_mfma_f32_32x32x16_bf16 v[104:119], v[120:123], v[72:75], v[104:119]
    v_mfma_f32_32x32x16_bf16 v[104:119], v[124:127], v[76:79], v[104:119]
    ds_read_b128 v[120:123], v8 offset:448
    ds_read_b128 v[124:127], v8 offset:480
    v_sub_f32 v88, v88, v11
    v_sub_f32 v89, v89, v11
    v_sub_f32 v90, v90, v11
    v_sub_f32 v91, v91, v11
    v_sub_f32 v92, v92, v11
    v_sub_f32 v93, v93, v11
    v_sub_f32 v94, v94, v11
    v_sub_f32 v95, v95, v11
    v_sub_f32 v96, v96, v11
    v_sub_f32 v97, v97, v11
    v_sub_f32 v98, v98, v11
    v_sub_f32 v99, v99, v11
    v_sub_f32 v100, v100, v11
    v_sub_f32 v101, v101, v11
    v_sub_f32 v102, v102, v11
    v_sub_f32 v103, v103, v11
    v_exp_f32 v88, v88
    v_exp_f32 v89, v89
    v_exp_f32 v90, v90
    v_exp_f32 v91, v91
    v_exp_f32 v92, v92
    v_exp_f32 v93, v93
    v_exp_f32 v94, v94
    v_exp_f32 v95, v95
    v_exp_f32 v96, v96
    v_exp_f32 v97, v97
    v_exp_f32 v98, v98
    v_exp_f32 v99, v99
    v_exp_f32 v100, v100
    v_exp_f32 v101, v101
    v_exp_f32 v102, v102
    v_exp_f32 v103, v103
    v_cvt_pk_bf16_f32 v88, v88, v89
    v_cvt_pk_bf16_f32 v89, v90, v91
    v_cvt_pk_bf16_f32 v90, v92, v93
    v_cvt_pk_bf16_f32 v91, v94, v95
    v_cvt_pk_bf16_f32 v92, v96, v97
    v_cvt_pk_bf16_f32 v93, v98, v99
    v_cvt_pk_bf16_f32 v94, v100, v101
    v_cvt_pk_bf16_f32 v95, v102, v103
    s_waitcnt lgkmcnt(0)
    v_mfma_f32_32x32x16_bf16 v[104:119], v[120:123], v[88:91], v[104:119]
    v_mfma_f32_32x32x16_bf16 v[104:119], v[124:127], v[92:95], v[104:119]
    v_add_u32 v3, s38, v1
    v_lshrrev_b32 v4, 4, v3
    v_mul_u32_u24 v4, 0x5000, v4
    v_and_b32 v3, 15, v3
    v_lshl_add_u32 v3, v3, 4, v4
    s_mul_i32 s39, s16, 20
    v_lshlrev_b32 v4, 2, v2
    v_add_u32 v4, s39, v4
    v_add_u32 v5, 0, v4
    v_lshrrev_b32 v6, 3, v5
    v_lshlrev_b32 v6, 8, v6
    v_and_b32 v5, 7, v5
    v_lshl_add_u32 v5, v5, 1, v6
    v_add_u32 v12, v3, v5
    v_add_u32 v5, 8, v4
    v_lshrrev_b32 v6, 3, v5
    v_lshlrev_b32 v6, 8, v6
    v_and_b32 v5, 7, v5
    v_lshl_add_u32 v5, v5, 1, v6
    v_add_u32 v13, v3, v5
    v_add_u32 v5, 16, v4
    v_lshrrev_b32 v6, 3, v5
    v_lshlrev_b32 v6, 8, v6
    v_and_b32 v5, 7, v5
    v_lshl_add_u32 v5, v5, 1, v6
    v_add_u32 v14, v3, v5
    v_cmp_eq_u32 vcc, 0, v2
    v_mov_b32 v5, 0x7fffffff
    s_nop 0
    v_cndmask_b32 v14, v5, v14, vcc
    v_rcp_f32 v11, v116
    s_nop 0
    v_mul_f32 v104, v104, v11
    v_mul_f32 v105, v105, v11
    v_mul_f32 v106, v106, v11
    v_mul_f32 v107, v107, v11
    v_mul_f32 v108, v108, v11
    v_mul_f32 v109, v109, v11
    v_mul_f32 v110, v110, v11
    v_mul_f32 v111, v111, v11
    v_mul_f32 v112, v112, v11
    v_mul_f32 v113, v113, v11
    v_mul_f32 v114, v114, v11
    v_mul_f32 v115, v115, v11
    v_cvt_pk_bf16_f32 v16, v104, v105
    v_cvt_pk_bf16_f32 v17, v106, v107
    buffer_store_dwordx2 v[16:17], v12, s[32:35], 0 offen sc1
    v_cvt_pk_bf16_f32 v18, v108, v109
    v_cvt_pk_bf16_f32 v19, v110, v111
    buffer_store_dwordx2 v[18:19], v13, s[32:35], 0 offen sc1
    v_cvt_pk_bf16_f32 v20, v112, v113
    v_cvt_pk_bf16_f32 v21, v114, v115
    buffer_store_dwordx2 v[20:21], v14, s[32:35], 0 offen sc1
    s_branch K2_END
K2_CONV2:
    s_sub_u32 s16, s2, 512
    s_lshl_b32 s16, s16, 1
    s_lshr_b32 s36, s3, 1
    s_add_u32 s16, s16, s36
    s_and_b32 s35, s3, 1
    s_mul_i32 s34, s36, 18112
    s_mov_b32 s32, s35
    s_lshl_b32 s17, s16, 12
    s_lshr_b32 s18, s16, 1
    s_lshl_b32 s18, s18, 2
    s_waitcnt lgkmcnt(0)
    s_load_dword s19, s[8:9], s18
    s_add_u32 s20, s6, s17
    s_addc_u32 s21, s7, 0
    s_mov_b32 s22, 0x1000
    s_mov_b32 s23, 0x20000
    s_add_u32 s37, s17, 0xc80000
    s_add_u32 s24, s4, s37
    s_addc_u32 s25, s5, 0
    s_cmp_eq_u32 s35, 0
    s_cselect_b32 s33, 2, 0
    s_lshl_b32 s26, s33, 1
    s_add_u32 s26, s26, 0x1000
    s_mov_b32 s27, 0x20000
    s_add_u32 s37, s17, 0xf00000
    s_add_u32 s28, s4, s37
    s_addc_u32 s29, s5, 0
    s_mov_b32 s30, 0x1000
    s_mov_b32 s31, 0x20000
    v_lshlrev_b32 v3, 4, v0
    s_mul_i32 s37, s35, 4576
    s_add_u32 s37, s37, s34
    s_add_u32 m0, s37, 8960
    v_add_u32 v4, 0x2000, v3
    buffer_load_dwordx4 v3, s[24:27], s33 offen lds
    buffer_load_dwordx4 v3, s[24:27], s33 offen offset:1024 lds
    buffer_load_dwordx4 v3, s[24:27], s33 offen offset:2048 lds
    buffer_load_dwordx4 v3, s[24:27], s33 offen offset:3072 lds
    s_add_u32 m0, s37, 13056
    s_mov_b64 exec, 0x0fffffff
    buffer_load_dwordx4 v4, s[24:27], 0 offen lds
    s_mov_b64 exec, -1
    s_mul_i32 s37, s35, 4480
    s_add_u32 s37, s37, s34
    s_mov_b32 m0, s37
    s_sub_u32 s38, s35, 16
    v_add_u32 v2, s38, v0
    v_lshlrev_b32 v2, 2, v2
    buffer_load_dword v2, s[20:23], 0 offen lds
    s_add_u32 m0, s37, 256
    s_lshl_b32 s38, s35, 2
    s_add_u32 s38, s38, 192
    v_add_u32 v2, s38, v3
    buffer_load_dwordx4 v2, s[20:23], 0 offen lds
    buffer_load_dwordx4 v2, s[20:23], 0 offen offset:1024 lds
    buffer_load_dwordx4 v2, s[20:23], 0 offen offset:2048 lds
    buffer_load_dwordx4 v2, s[20:23], 0 offen offset:3072 lds
    v_and_b32 v1, 15, v0
    v_lshrrev_b32 v2, 4, v0
    v_add_u32 v4, 1, v1
    v_and_b32 v5, 1, v4
    v_lshrrev_b32 v4, 1, v4
    v_lshlrev_b32 v4, 3, v4
    v_lshl_add_u32 v4, v2, 4, v4
    v_mul_u32_u24 v5, 4480, v5
    s_mul_i32 s37, s32, 256
    s_add_u32 s37, s37, s34
    v_add3_u32 v6, v4, v5, s37
    v_and_b32 v4, 1, v1
    v_mul_u32_u24 v4, 4576, v4
    v_lshrrev_b32 v5, 1, v1
    v_lshlrev_b32 v5, 6, v5
    v_sub_u32 v4, v4, v5
    v_lshlrev_b32 v5, 4, v2
    v_add3_u32 v7, v4, v5, s37
    v_add_u32 v7, 9408, v7
    v_lshlrev_b32 v4, 2, v2
    v_add_u32 v4, v4, v1
    v_sub_u32 v4, 15, v4
    s_waitcnt lgkmcnt(0)
    s_lshr_b32 s38, s19, 16
    s_and_b32 s39, s19, 0xffff
    s_bitcmp1_b32 s16, 0
    s_cselect_b32 s38, s38, s39
    s_cmp_eq_u32 s32, 0
    s_cselect_b32 s38, s38, 0
    v_mov_b32 v5, s38
    v_cmp_eq_u32 vcc, 0, v4
    s_nop 1
    v_cndmask_b32 v112, 0, v5, vcc
    v_cmp_eq_u32 vcc, 1, v4
    s_nop 1
    v_cndmask_b32 v113, 0, v5, vcc
    v_cmp_eq_u32 vcc, 2, v4
    s_nop 1
    v_cndmask_b32 v114, 0, v5, vcc
    v_cmp_eq_u32 vcc, 3, v4
    s_nop 1
    v_cndmask_b32 v115, 0, v5, vcc
    v_mov_b32 v16, 0
    v_mov_b32 v17, 0
    v_mov_b32 v18, 0
    v_mov_b32 v19, 0
    v_mov_b32 v20, 0
    v_mov_b32 v21, 0
    v_mov_b32 v22, 0
    v_mov_b32 v23, 0
    v_mov_b32 v24, 0
    v_mov_b32 v25, 0
    v_mov_b32 v26, 0
    v_mov_b32 v27, 0
    v_mov_b32 v28, 0
    v_mov_b32 v29, 0
    v_mov_b32 v30, 0
    v_mov_b32 v31, 0
    v_mov_b32 v32, 0
    v_mov_b32 v33, 0
    v_mov_b32 v34, 0
    v_mov_b32 v35, 0
    v_mov_b32 v36, 0
    v_mov_b32 v37, 0
    v_mov_b32 v38, 0
    v_mov_b32 v39, 0
    v_mov_b32 v40, 0
    v_mov_b32 v41, 0
    v_mov_b32 v42, 0
    v_mov_b32 v43, 0
    v_mov_b32 v44, 0
    v_mov_b32 v45, 0
    v_mov_b32 v46, 0
    v_mov_b32 v47, 0
    v_mov_b32 v8, s34
    s_waitcnt vmcnt(0)
    s_cmp_lg_u32 s35, 0
    s_cbranch_scc1 K2C_NOZ2
    ds_write_b16 v8, v16 offset:13054
    s_waitcnt lgkmcnt(0)
K2C_NOZ2:
    s_barrier
    ds_read_b64 v[76:77], v6 offset:3584
    ds_read_b64 v[78:79], v6 offset:3592
    ds_read_b128 v[80:83], v7 offset:3584
    ds_read_b64 v[72:73], v6 offset:3072
    ds_read_b64 v[74:75], v6 offset:3080
    ds_read_b128 v[84:87], v7 offset:3072
    ds_read_b64 v[68:69], v6 offset:2560
    ds_read_b64 v[70:71], v6 offset:2568
    ds_read_b128 v[88:91], v7 offset:2560
    ds_read_b64 v[64:65], v6 offset:2048
    ds_read_b64 v[66:67], v6 offset:2056
    ds_read_b128 v[92:95], v7 offset:2048
    ds_read_b64 v[60:61], v6 offset:1536
    ds_read_b64 v[62:63], v6 offset:1544
    ds_read_b128 v[96:99], v7 offset:1536
    ds_read_b64 v[56:57], v6 offset:1024
    ds_read_b64 v[58:59], v6 offset:1032
    ds_read_b128 v[100:103], v7 offset:1024
    ds_read_b64 v[52:53], v6 offset:512
    ds_read_b64 v[54:55], v6 offset:520
    ds_read_b128 v[104:107], v7 offset:512
    ds_read_b64 v[48:49], v6 offset:0
    ds_read_b64 v[50:51], v6 offset:8
    ds_read_b128 v[108:111], v7 offset:0
    s_waitcnt lgkmcnt(15)
    v_mfma_f32_16x16x32_bf16 v[44:47], v[76:79], v[80:83], v[44:47]
    ds_read_b64 v[76:77], v6 offset:3648
    ds_read_b64 v[78:79], v6 offset:3656
    s_waitcnt lgkmcnt(15)
    v_mfma_f32_16x16x32_bf16 v[40:43], v[72:75], v[80:83], v[40:43]
    v_mfma_f32_16x16x32_bf16 v[44:47], v[72:75], v[84:87], v[44:47]
    ds_read_b64 v[72:73], v6 offset:3136
    ds_read_b64 v[74:75], v6 offset:3144
    s_waitcnt lgkmcnt(15)
    v_mfma_f32_16x16x32_bf16 v[36:39], v[68:71], v[80:83], v[36:39]
    v_mfma_f32_16x16x32_bf16 v[40:43], v[68:71], v[84:87], v[40:43]
    v_mfma_f32_16x16x32_bf16 v[44:47], v[68:71], v[88:91], v[44:47]
    ds_read_b64 v[68:69], v6 offset:2624
    ds_read_b64 v[70:71], v6 offset:2632
    s_waitcnt lgkmcnt(15)
    v_mfma_f32_16x16x32_bf16 v[32:35], v[64:67], v[80:83], v[32:35]
    v_mfma_f32_16x16x32_bf16 v[36:39], v[64:67], v[84:87], v[36:39]
    v_mfma_f32_16x16x32_bf16 v[40:43], v[64:67], v[88:91], v[40:43]
    v_mfma_f32_16x16x32_bf16 v[44:47], v[64:67], v[92:95], v[44:47]
    ds_read_b64 v[64:65], v6 offset:2112
    ds_read_b64 v[66:67], v6 offset:2120
    s_waitcnt lgkmcnt(15)
    v_mfma_f32_16x16x32_bf16 v[28:31], v[60:63], v[80:83], v[28:31]
    v_mfma_f32_16x16x32_bf16 v[32:35], v[60:63], v[84:87], v[32:35]
    v_mfma_f32_16x16x32_bf16 v[36:39], v[60:63], v[88:91], v[36:39]
    v_mfma_f32_16x16x32_bf16 v[40:43], v[60:63], v[92:95], v[40:43]
    v_mfma_f32_16x16x32_bf16 v[44:47], v[60:63], v[96:99], v[44:47]
    ds_read_b64 v[60:61], v6 offset:1600
    ds_read_b64 v[62:63], v6 offset:1608
    s_waitcnt lgkmcnt(15)
    v_mfma_f32_16x16x32_bf16 v[24:27], v[56:59], v[80:83], v[24:27]
    v_mfma_f32_16x16x32_bf16 v[28:31], v[56:59], v[84:87], v[28:31]
    v_mfma_f32_16x16x32_bf16 v[32:35], v[56:59], v[88:91], v[32:35]
    v_mfma_f32_16x16x32_bf16 v[36:39], v[56:59], v[92:95], v[36:39]
    v_mfma_f32_16x16x32_bf16 v[40:43], v[56:59], v[96:99], v[40:43]
    v_mfma_f32_16x16x32_bf16 v[44:47], v[56:59], v[100:103], v[44:47]
    ds_read_b64 v[56:57], v6 offset:1088
    ds_read_b64 v[58:59], v6 offset:1096
    s_waitcnt lgkmcnt(15)
    v_mfma_f32_16x16x32_bf16 v[20:23], v[52:55], v[80:83], v[20:23]
    v_mfma_f32_16x16x32_bf16 v[24:27], v[52:55], v[84:87], v[24:27]
    v_mfma_f32_16x16x32_bf16 v[28:31], v[52:55], v[88:91], v[28:31]
    v_mfma_f32_16x16x32_bf16 v[32:35], v[52:55], v[92:95], v[32:35]
    v_mfma_f32_16x16x32_bf16 v[36:39], v[52:55], v[96:99], v[36:39]
    v_mfma_f32_16x16x32_bf16 v[40:43], v[52:55], v[100:103], v[40:43]
    v_mfma_f32_16x16x32_bf16 v[44:47], v[52:55], v[104:107], v[44:47]
    ds_read_b64 v[52:53], v6 offset:576
    ds_read_b64 v[54:55], v6 offset:584
    s_waitcnt lgkmcnt(14)
    s_cmp_lg_u32 s32, 0
    s_cbranch_scc1 K2C_ND2
    v_mfma_f32_16x16x32_bf16 v[16:19], v[112:115], v[80:83], v[16:19]
    v_mfma_f32_16x16x32_bf16 v[20:23], v[112:115], v[84:87], v[20:23]
    v_mfma_f32_16x16x32_bf16 v[24:27], v[112:115], v[88:91], v[24:27]
    v_mfma_f32_16x16x32_bf16 v[28:31], v[112:115], v[92:95], v[28:31]
    v_mfma_f32_16x16x32_bf16 v[32:35], v[112:115], v[96:99], v[32:35]
    v_mfma_f32_16x16x32_bf16 v[36:39], v[112:115], v[100:103], v[36:39]
    v_mfma_f32_16x16x32_bf16 v[40:43], v[112:115], v[104:107], v[40:43]
    v_mfma_f32_16x16x32_bf16 v[44:47], v[112:115], v[108:111], v[44:47]
K2C_ND2:
    v_mfma_f32_16x16x32_bf16 v[16:19], v[48:51], v[80:83], v[16:19]
    ds_read_b128 v[80:83], v7 offset:3648
    v_mfma_f32_16x16x32_bf16 v[20:23], v[48:51], v[84:87], v[20:23]
    ds_read_b128 v[84:87], v7 offset:3136
    v_mfma_f32_16x16x32_bf16 v[24:27], v[48:51], v[88:91], v[24:27]
    ds_read_b128 v[88:91], v7 offset:2624
    v_mfma_f32_16x16x32_bf16 v[28:31], v[48:51], v[92:95], v[28:31]
    ds_read_b128 v[92:95], v7 offset:2112
    v_mfma_f32_16x16x32_bf16 v[32:35], v[48:51], v[96:99], v[32:35]
    ds_read_b128 v[96:99], v7 offset:1600
    v_mfma_f32_16x16x32_bf16 v[36:39], v[48:51], v[100:103], v[36:39]
    ds_read_b128 v[100:103], v7 offset:1088
    v_mfma_f32_16x16x32_bf16 v[40:43], v[48:51], v[104:107], v[40:43]
    ds_read_b128 v[104:107], v7 offset:576
    v_mfma_f32_16x16x32_bf16 v[44:47], v[48:51], v[108:111], v[44:47]
    ds_read_b128 v[108:111], v7 offset:64
    ds_read_b64 v[48:49], v6 offset:64
    ds_read_b64 v[50:51], v6 offset:72
    s_waitcnt lgkmcnt(9)
    v_mfma_f32_16x16x32_bf16 v[44:47], v[76:79], v[80:83], v[44:47]
    ds_read_b64 v[76:77], v6 offset:3712
    ds_read_b64 v[78:79], v6 offset:3720
    s_waitcnt lgkmcnt(10)
    v_mfma_f32_16x16x32_bf16 v[40:43], v[72:75], v[80:83], v[40:43]
    v_mfma_f32_16x16x32_bf16 v[44:47], v[72:75], v[84:87], v[44:47]
    ds_read_b64 v[72:73], v6 offset:3200
    ds_read_b64 v[74:75], v6 offset:3208
    s_waitcnt lgkmcnt(11)
    v_mfma_f32_16x16x32_bf16 v[36:39], v[68:71], v[80:83], v[36:39]
    v_mfma_f32_16x16x32_bf16 v[40:43], v[68:71], v[84:87], v[40:43]
    v_mfma_f32_16x16x32_bf16 v[44:47], v[68:71], v[88:91], v[44:47]
    ds_read_b64 v[68:69], v6 offset:2688
    ds_read_b64 v[70:71], v6 offset:2696
    s_waitcnt lgkmcnt(12)
    v_mfma_f32_16x16x32_bf16 v[32:35], v[64:67], v[80:83], v[32:35]
    v_mfma_f32_16x16x32_bf16 v[36:39], v[64:67], v[84:87], v[36:39]
    v_mfma_f32_16x16x32_bf16 v[40:43], v[64:67], v[88:91], v[40:43]
    v_mfma_f32_16x16x32_bf16 v[44:47], v[64:67], v[92:95], v[44:47]
    ds_read_b64 v[64:65], v6 offset:2176
    ds_read_b64 v[66:67], v6 offset:2184
    s_waitcnt lgkmcnt(13)
    v_mfma_f32_16x16x32_bf16 v[28:31], v[60:63], v[80:83], v[28:31]
    v_mfma_f32_16x16x32_bf16 v[32:35], v[60:63], v[84:87], v[32:35]
    v_mfma_f32_16x16x32_bf16 v[36:39], v[60:63], v[88:91], v[36:39]
    v_mfma_f32_16x16x32_bf16 v[40:43], v[60:63], v[92:95], v[40:43]
    v_mfma_f32_16x16x32_bf16 v[44:47], v[60:63], v[96:99], v[44:47]
    ds_read_b64 v[60:61], v6 offset:1664
    ds_read_b64 v[62:63], v6 offset:1672
    s_waitcnt lgkmcnt(14)
    v_mfma_f32_16x16x32_bf16 v[24:27], v[56:59], v[80:83], v[24:27]
    v_mfma_f32_16x16x32_bf16 v[28:31], v[56:59], v[84:87], v[28:31]
    v_mfma_f32_16x16x32_bf16 v[32:35], v[56:59], v[88:91], v[32:35]
    v_mfma_f32_16x16x32_bf16 v[36:39], v[56:59], v[92:95], v[36:39]
    v_mfma_f32_16x16x32_bf16 v[40:43], v[56:59], v[96:99], v[40:43]
    v_mfma_f32_16x16x32_bf16 v[44:47], v[56:59], v[100:103], v[44:47]
    ds_read_b64 v[56:57], v6 offset:1152
    ds_read_b64 v[58:59], v6 offset:1160
    s_waitcnt lgkmcnt(15)
    v_mfma_f32_16x16x32_bf16 v[20:23], v[52:55], v[80:83], v[20:23]
    v_mfma_f32_16x16x32_bf16 v[24:27], v[52:55], v[84:87], v[24:27]
    v_mfma_f32_16x16x32_bf16 v[28:31], v[52:55], v[88:91], v[28:31]
    v_mfma_f32_16x16x32_bf16 v[32:35], v[52:55], v[92:95], v[32:35]
    v_mfma_f32_16x16x32_bf16 v[36:39], v[52:55], v[96:99], v[36:39]
    v_mfma_f32_16x16x32_bf16 v[40:43], v[52:55], v[100:103], v[40:43]
    v_mfma_f32_16x16x32_bf16 v[44:47], v[52:55], v[104:107], v[44:47]
    ds_read_b64 v[52:53], v6 offset:640
    ds_read_b64 v[54:55], v6 offset:648
    s_waitcnt lgkmcnt(14)
    v_mfma_f32_16x16x32_bf16 v[16:19], v[48:51], v[80:83], v[16:19]
    ds_read_b128 v[80:83], v7 offset:3712
    v_mfma_f32_16x16x32_bf16 v[20:23], v[48:51], v[84:87], v[20:23]
    ds_read_b128 v[84:87], v7 offset:3200
    v_mfma_f32_16x16x32_bf16 v[24:27], v[48:51], v[88:91], v[24:27]
    ds_read_b128 v[88:91], v7 offset:2688
    v_mfma_f32_16x16x32_bf16 v[28:31], v[48:51], v[92:95], v[28:31]
    ds_read_b128 v[92:95], v7 offset:2176
    v_mfma_f32_16x16x32_bf16 v[32:35], v[48:51], v[96:99], v[32:35]
    ds_read_b128 v[96:99], v7 offset:1664
    v_mfma_f32_16x16x32_bf16 v[36:39], v[48:51], v[100:103], v[36:39]
    ds_read_b128 v[100:103], v7 offset:1152
    v_mfma_f32_16x16x32_bf16 v[40:43], v[48:51], v[104:107], v[40:43]
    ds_read_b128 v[104:107], v7 offset:640
    v_mfma_f32_16x16x32_bf16 v[44:47], v[48:51], v[108:111], v[44:47]
    ds_read_b128 v[108:111], v7 offset:128
    ds_read_b64 v[48:49], v6 offset:128
    ds_read_b64 v[50:51], v6 offset:136
    s_waitcnt lgkmcnt(9)
    v_mfma_f32_16x16x32_bf16 v[44:47], v[76:79], v[80:83], v[44:47]
    ds_read_b64 v[76:77], v6 offset:3776
    ds_read_b64 v[78:79], v6 offset:3784
    s_waitcnt lgkmcnt(10)
    v_mfma_f32_16x16x32_bf16 v[40:43], v[72:75], v[80:83], v[40:43]
    v_mfma_f32_16x16x32_bf16 v[44:47], v[72:75], v[84:87], v[44:47]
    ds_read_b64 v[72:73], v6 offset:3264
    ds_read_b64 v[74:75], v6 offset:3272
    s_waitcnt lgkmcnt(11)
    v_mfma_f32_16x16x32_bf16 v[36:39], v[68:71], v[80:83], v[36:39]
    v_mfma_f32_16x16x32_bf16 v[40:43], v[68:71], v[84:87], v[40:43]
    v_mfma_f32_16x16x32_bf16 v[44:47], v[68:71], v[88:91], v[44:47]
    ds_read_b64 v[68:69], v6 offset:2752
    ds_read_b64 v[70:71], v6 offset:2760
    s_waitcnt lgkmcnt(12)
    v_mfma_f32_16x16x32_bf16 v[32:35], v[64:67], v[80:83], v[32:35]
    v_mfma_f32_16x16x32_bf16 v[36:39], v[64:67], v[84:87], v[36:39]
    v_mfma_f32_16x16x32_bf16 v[40:43], v[64:67], v[88:91], v[40:43]
    v_mfma_f32_16x16x32_bf16 v[44:47], v[64:67], v[92:95], v[44:47]
    ds_read_b64 v[64:65], v6 offset:2240
    ds_read_b64 v[66:67], v6 offset:2248
    s_waitcnt lgkmcnt(13)
    v_mfma_f32_16x16x32_bf16 v[28:31], v[60:63], v[80:83], v[28:31]
    v_mfma_f32_16x16x32_bf16 v[32:35], v[60:63], v[84:87], v[32:35]
    v_mfma_f32_16x16x32_bf16 v[36:39], v[60:63], v[88:91], v[36:39]
    v_mfma_f32_16x16x32_bf16 v[40:43], v[60:63], v[92:95], v[40:43]
    v_mfma_f32_16x16x32_bf16 v[44:47], v[60:63], v[96:99], v[44:47]
    ds_read_b64 v[60:61], v6 offset:1728
    ds_read_b64 v[62:63], v6 offset:1736
    s_waitcnt lgkmcnt(14)
    v_mfma_f32_16x16x32_bf16 v[24:27], v[56:59], v[80:83], v[24:27]
    v_mfma_f32_16x16x32_bf16 v[28:31], v[56:59], v[84:87], v[28:31]
    v_mfma_f32_16x16x32_bf16 v[32:35], v[56:59], v[88:91], v[32:35]
    v_mfma_f32_16x16x32_bf16 v[36:39], v[56:59], v[92:95], v[36:39]
    v_mfma_f32_16x16x32_bf16 v[40:43], v[56:59], v[96:99], v[40:43]
    v_mfma_f32_16x16x32_bf16 v[44:47], v[56:59], v[100:103], v[44:47]
    ds_read_b64 v[56:57], v6 offset:1216
    ds_read_b64 v[58:59], v6 offset:1224
    s_waitcnt lgkmcnt(15)
    v_mfma_f32_16x16x32_bf16 v[20:23], v[52:55], v[80:83], v[20:23]
    v_mfma_f32_16x16x32_bf16 v[24:27], v[52:55], v[84:87], v[24:27]
    v_mfma_f32_16x16x32_bf16 v[28:31], v[52:55], v[88:91], v[28:31]
    v_mfma_f32_16x16x32_bf16 v[32:35], v[52:55], v[92:95], v[32:35]
    v_mfma_f32_16x16x32_bf16 v[36:39], v[52:55], v[96:99], v[36:39]
    v_mfma_f32_16x16x32_bf16 v[40:43], v[52:55], v[100:103], v[40:43]
    v_mfma_f32_16x16x32_bf16 v[44:47], v[52:55], v[104:107], v[44:47]
    ds_read_b64 v[52:53], v6 offset:704
    ds_read_b64 v[54:55], v6 offset:712
    s_waitcnt lgkmcnt(14)
    v_mfma_f32_16x16x32_bf16 v[16:19], v[48:51], v[80:83], v[16:19]
    ds_read_b128 v[80:83], v7 offset:3776
    v_mfma_f32_16x16x32_bf16 v[20:23], v[48:51], v[84:87], v[20:23]
    ds_read_b128 v[84:87], v7 offset:3264
    v_mfma_f32_16x16x32_bf16 v[24:27], v[48:51], v[88:91], v[24:27]
    ds_read_b128 v[88:91], v7 offset:2752
    v_mfma_f32_16x16x32_bf16 v[28:31], v[48:51], v[92:95], v[28:31]
    ds_read_b128 v[92:95], v7 offset:2240
    v_mfma_f32_16x16x32_bf16 v[32:35], v[48:51], v[96:99], v[32:35]
    ds_read_b128 v[96:99], v7 offset:1728
    v_mfma_f32_16x16x32_bf16 v[36:39], v[48:51], v[100:103], v[36:39]
    ds_read_b128 v[100:103], v7 offset:1216
    v_mfma_f32_16x16x32_bf16 v[40:43], v[48:51], v[104:107], v[40:43]
    ds_read_b128 v[104:107], v7 offset:704
    v_mfma_f32_16x16x32_bf16 v[44:47], v[48:51], v[108:111], v[44:47]
    ds_read_b128 v[108:111], v7 offset:192
    ds_read_b64 v[48:49], v6 offset:192
    ds_read_b64 v[50:51], v6 offset:200
    s_waitcnt lgkmcnt(9)
    v_mfma_f32_16x16x32_bf16 v[44:47], v[76:79], v[80:83], v[44:47]
    s_waitcnt lgkmcnt(8)
    v_mfma_f32_16x16x32_bf16 v[40:43], v[72:75], v[80:83], v[40:43]
    v_mfma_f32_16x16x32_bf16 v[44:47], v[72:75], v[84:87], v[44:47]
    s_waitcnt lgkmcnt(7)
    v_mfma_f32_16x16x32_bf16 v[36:39], v[68:71], v[80:83], v[36:39]
    v_mfma_f32_16x16x32_bf16 v[40:43], v[68:71], v[84:87], v[40:43]
    v_mfma_f32_16x16x32_bf16 v[44:47], v[68:71], v[88:91], v[44:47]
    s_waitcnt lgkmcnt(6)
    v_mfma_f32_16x16x32_bf16 v[32:35], v[64:67], v[80:83], v[32:35]
    v_mfma_f32_16x16x32_bf16 v[36:39], v[64:67], v[84:87], v[36:39]
    v_mfma_f32_16x16x32_bf16 v[40:43], v[64:67], v[88:91], v[40:43]
    v_mfma_f32_16x16x32_bf16 v[44:47], v[64:67], v[92:95], v[44:47]
    s_waitcnt lgkmcnt(5)
    v_mfma_f32_16x16x32_bf16 v[28:31], v[60:63], v[80:83], v[28:31]
    v_mfma_f32_16x16x32_bf16 v[32:35], v[60:63], v[84:87], v[32:35]
    v_mfma_f32_16x16x32_bf16 v[36:39], v[60:63], v[88:91], v[36:39]
    v_mfma_f32_16x16x32_bf16 v[40:43], v[60:63], v[92:95], v[40:43]
    v_mfma_f32_16x16x32_bf16 v[44:47], v[60:63], v[96:99], v[44:47]
    s_waitcnt lgkmcnt(4)
    v_mfma_f32_16x16x32_bf16 v[24:27], v[56:59], v[80:83], v[24:27]
    v_mfma_f32_16x16x32_bf16 v[28:31], v[56:59], v[84:87], v[28:31]
    v_mfma_f32_16x16x32_bf16 v[32:35], v[56:59], v[88:91], v[32:35]
    v_mfma_f32_16x16x32_bf16 v[36:39], v[56:59], v[92:95], v[36:39]
    v_mfma_f32_16x16x32_bf16 v[40:43], v[56:59], v[96:99], v[40:43]
    v_mfma_f32_16x16x32_bf16 v[44:47], v[56:59], v[100:103], v[44:47]
    s_waitcnt lgkmcnt(3)
    v_mfma_f32_16x16x32_bf16 v[20:23], v[52:55], v[80:83], v[20:23]
    v_mfma_f32_16x16x32_bf16 v[24:27], v[52:55], v[84:87], v[24:27]
    v_mfma_f32_16x16x32_bf16 v[28:31], v[52:55], v[88:91], v[28:31]
    v_mfma_f32_16x16x32_bf16 v[32:35], v[52:55], v[92:95], v[32:35]
    v_mfma_f32_16x16x32_bf16 v[36:39], v[52:55], v[96:99], v[36:39]
    v_mfma_f32_16x16x32_bf16 v[40:43], v[52:55], v[100:103], v[40:43]
    v_mfma_f32_16x16x32_bf16 v[44:47], v[52:55], v[104:107], v[44:47]
    s_waitcnt lgkmcnt(0)
    s_barrier
    v_mfma_f32_16x16x32_bf16 v[16:19], v[48:51], v[80:83], v[16:19]
    v_mfma_f32_16x16x32_bf16 v[20:23], v[48:51], v[84:87], v[20:23]
    v_mfma_f32_16x16x32_bf16 v[24:27], v[48:51], v[88:91], v[24:27]
    v_mfma_f32_16x16x32_bf16 v[28:31], v[48:51], v[92:95], v[28:31]
    v_mfma_f32_16x16x32_bf16 v[32:35], v[48:51], v[96:99], v[32:35]
    v_mfma_f32_16x16x32_bf16 v[36:39], v[48:51], v[100:103], v[36:39]
    v_mfma_f32_16x16x32_bf16 v[40:43], v[48:51], v[104:107], v[40:43]
    v_mfma_f32_16x16x32_bf16 v[44:47], v[48:51], v[108:111], v[44:47]
    v_lshlrev_b32 v3, 4, v0
    s_lshl_b32 s37, s3, 13
    v_add_u32 v4, s37, v3
    ds_write_b128 v4, v[16:19] offset:0
    ds_write_b128 v4, v[20:23] offset:1024
    ds_write_b128 v4, v[24:27] offset:2048
    ds_write_b128 v4, v[28:31] offset:3072
    ds_write_b128 v4, v[32:35] offset:4096
    ds_write_b128 v4, v[36:39] offset:5120
    ds_write_b128 v4, v[40:43] offset:6144
    ds_write_b128 v4, v[44:47] offset:7168
    s_lshl_b32 s37, s36, 14
    s_lshl_b32 s38, s35, 12
    s_add_u32 s37, s37, s38
    v_add_u32 v4, s37, v3
    s_waitcnt lgkmcnt(0)
    s_barrier
    ds_read_b128 v[48:51], v4 offset:0
    ds_read_b128 v[52:55], v4 offset:8192
    ds_read_b128 v[56:59], v4 offset:1024
    ds_read_b128 v[60:63], v4 offset:9216
    ds_read_b128 v[64:67], v4 offset:2048
    ds_read_b128 v[68:71], v4 offset:10240
    ds_read_b128 v[72:75], v4 offset:3072
    ds_read_b128 v[76:79], v4 offset:11264
    v_lshrrev_b32 v5, 1, v1
    v_lshlrev_b32 v5, 6, v5
    v_and_b32 v8, 1, v1
    v_lshlrev_b32 v8, 3, v8
    v_lshlrev_b32 v9, 4, v2
    v_add3_u32 v5, v5, v8, v9
    s_mul_i32 s37, s32, 2048
    v_add_u32 v5, s37, v5
    s_waitcnt lgkmcnt(6)
    v_add_f32 v48, v48, v52
    v_add_f32 v49, v49, v53
    v_add_f32 v50, v50, v54
    v_add_f32 v51, v51, v55
    v_cvt_pk_bf16_f32 v10, v48, v49
    v_cvt_pk_bf16_f32 v11, v50, v51
    buffer_store_dwordx2 v[10:11], v5, s[28:31], 0 offen offset:0 sc1
    s_waitcnt lgkmcnt(4)
    v_add_f32 v56, v56, v60
    v_add_f32 v57, v57, v61
    v_add_f32 v58, v58, v62
    v_add_f32 v59, v59, v63
    v_cvt_pk_bf16_f32 v12, v56, v57
    v_cvt_pk_bf16_f32 v13, v58, v59
    buffer_store_dwordx2 v[12:13], v5, s[28:31], 0 offen offset:512 sc1
    s_waitcnt lgkmcnt(2)
    v_add_f32 v64, v64, v68
    v_add_f32 v65, v65, v69
    v_add_f32 v66, v66, v70
    v_add_f32 v67, v67, v71
    v_cvt_pk_bf16_f32 v14, v64, v65
    v_cvt_pk_bf16_f32 v15, v66, v67
    buffer_store_dwordx2 v[14:15], v5, s[28:31], 0 offen offset:1024 sc1
    s_waitcnt lgkmcnt(0)
    v_add_f32 v72, v72, v76
    v_add_f32 v73, v73, v77
    v_add_f32 v74, v74, v78
    v_add_f32 v75, v75, v79
    v_cvt_pk_bf16_f32 v16, v72, v73
    v_cvt_pk_bf16_f32 v17, v74, v75
    buffer_store_dwordx2 v[16:17], v5, s[28:31], 0 offen offset:1536 sc1
    s_branch K2_END
K2_CONV1:
    s_sub_u32 s16, s2, 256
    s_lshr_b32 s36, s3, 1
    s_and_b32 s35, s3, 1
    s_mov_b32 s34, 0
    s_mov_b32 s32, s3
    s_lshl_b32 s17, s16, 12
    s_lshr_b32 s18, s16, 1
    s_lshl_b32 s18, s18, 2
    s_waitcnt lgkmcnt(0)
    s_load_dword s19, s[8:9], s18
    s_add_u32 s20, s6, s17
    s_addc_u32 s21, s7, 0
    s_mov_b32 s22, 0x1000
    s_mov_b32 s23, 0x20000
    s_add_u32 s37, s17, 0xc80000
    s_add_u32 s24, s4, s37
    s_addc_u32 s25, s5, 0
    s_cmp_eq_u32 s35, 0
    s_cselect_b32 s33, 2, 0
    s_lshl_b32 s26, s33, 1
    s_add_u32 s26, s26, 0x1000
    s_mov_b32 s27, 0x20000
    s_add_u32 s37, s17, 0xf00000
    s_add_u32 s28, s4, s37
    s_addc_u32 s29, s5, 0
    s_mov_b32 s30, 0x1000
    s_mov_b32 s31, 0x20000
    v_lshlrev_b32 v3, 4, v0
    s_cmp_eq_u32 s36, 0
    s_cbranch_scc1 K2C_H1
    s_mul_i32 s37, s35, 4576
    s_add_u32 s37, s37, s34
    s_add_u32 m0, s37, 8960
    v_add_u32 v4, 0x2000, v3
    buffer_load_dwordx4 v3, s[24:27], s33 offen lds
    buffer_load_dwordx4 v3, s[24:27], s33 offen offset:1024 lds
    buffer_load_dwordx4 v3, s[24:27], s33 offen offset:2048 lds
    buffer_load_dwordx4 v3, s[24:27], s33 offen offset:3072 lds
    s_add_u32 m0, s37, 13056
    s_mov_b64 exec, 0x0fffffff
    buffer_load_dwordx4 v4, s[24:27], 0 offen lds
    s_mov_b64 exec, -1
    s_branch K2C_L1
K2C_H1:
    s_mul_i32 s37, s35, 4480
    s_add_u32 s37, s37, s34
    s_mov_b32 m0, s37
    s_sub_u32 s38, s35, 16
    v_add_u32 v2, s38, v0
    v_lshlrev_b32 v2, 2, v2
    buffer_load_dword v2, s[20:23], 0 offen lds
    s_add_u32 m0, s37, 256
    s_lshl_b32 s38, s35, 2
    s_add_u32 s38, s38, 192
    v_add_u32 v2, s38, v3
    buffer_load_dwordx4 v2, s[20:23], 0 offen lds
    buffer_load_dwordx4 v2, s[20:23], 0 offen offset:1024 lds
    buffer_load_dwordx4 v2, s[20:23], 0 offen offset:2048 lds
    buffer_load_dwordx4 v2, s[20:23], 0 offen offset:3072 lds
K2C_L1:
    v_and_b32 v1, 15, v0
    v_lshrrev_b32 v2, 4, v0
    v_add_u32 v4, 1, v1
    v_and_b32 v5, 1, v4
    v_lshrrev_b32 v4, 1, v4
    v_lshlrev_b32 v4, 3, v4
    v_lshl_add_u32 v4, v2, 4, v4
    v_mul_u32_u24 v5, 4480, v5
    s_mul_i32 s37, s32, 128
    s_add_u32 s37, s37, s34
    v_add3_u32 v6, v4, v5, s37
    v_and_b32 v4, 1, v1
    v_mul_u32_u24 v4, 4576, v4
    v_lshrrev_b32 v5, 1, v1
    v_lshlrev_b32 v5, 6, v5
    v_sub_u32 v4, v4, v5
    v_lshlrev_b32 v5, 4, v2
    v_add3_u32 v7, v4, v5, s37
    v_add_u32 v7, 9408, v7
    v_lshlrev_b32 v4, 2, v2
    v_add_u32 v4, v4, v1
    v_sub_u32 v4, 15, v4
    s_waitcnt lgkmcnt(0)
    s_lshr_b32 s38, s19, 16
    s_and_b32 s39, s19, 0xffff
    s_bitcmp1_b32 s16, 0
    s_cselect_b32 s38, s38, s39
    s_cmp_eq_u32 s32, 0
    s_cselect_b32 s38, s38, 0
    v_mov_b32 v5, s38
    v_cmp_eq_u32 vcc, 0, v4
    s_nop 1
    v_cndmask_b32 v112, 0, v5, vcc
    v_cmp_eq_u32 vcc, 1, v4
    s_nop 1
    v_cndmask_b32 v113, 0, v5, vcc
    v_cmp_eq_u32 vcc, 2, v4
    s_nop 1
    v_cndmask_b32 v114, 0, v5, vcc
    v_cmp_eq_u32 vcc, 3, v4
    s_nop 1
    v_cndmask_b32 v115, 0, v5, vcc
    v_mov_b32 v16, 0
    v_mov_b32 v17, 0
    v_mov_b32 v18, 0
    v_mov_b32 v19, 0
    v_mov_b32 v20, 0
    v_mov_b32 v21, 0
    v_mov_b32 v22, 0
    v_mov_b32 v23, 0
    v_mov_b32 v24, 0
    v_mov_b32 v25, 0
    v_mov_b32 v26, 0
    v_mov_b32 v27, 0
    v_mov_b32 v28, 0
    v_mov_b32 v29, 0
    v_mov_b32 v30, 0
    v_mov_b32 v31, 0
    v_mov_b32 v32, 0
    v_mov_b32 v33, 0
    v_mov_b32 v34, 0
    v_mov_b32 v35, 0
    v_mov_b32 v36, 0
    v_mov_b32 v37, 0
    v_mov_b32 v38, 0
    v_mov_b32 v39, 0
    v_mov_b32 v40, 0
    v_mov_b32 v41, 0
    v_mov_b32 v42, 0
    v_mov_b32 v43, 0
    v_mov_b32 v44, 0
    v_mov_b32 v45, 0
    v_mov_b32 v46, 0
    v_mov_b32 v47, 0
    v_mov_b32 v8, s34
    s_waitcnt vmcnt(0)
    s_cmp_lg_u32 s3, 2
    s_cbranch_scc1 K2C_NOZ1
    ds_write_b16 v8, v16 offset:13054
    s_waitcnt lgkmcnt(0)
K2C_NOZ1:
    s_barrier
    ds_read_b64 v[76:77], v6 offset:3584
    ds_read_b64 v[78:79], v6 offset:3592
    ds_read_b128 v[80:83], v7 offset:3584
    ds_read_b64 v[72:73], v6 offset:3072
    ds_read_b64 v[74:75], v6 offset:3080
    ds_read_b128 v[84:87], v7 offset:3072
    ds_read_b64 v[68:69], v6 offset:2560
    ds_read_b64 v[70:71], v6 offset:2568
    ds_read_b128 v[88:91], v7 offset:2560
    ds_read_b64 v[64:65], v6 offset:2048
    ds_read_b64 v[66:67], v6 offset:2056
    ds_read_b128 v[92:95], v7 offset:2048
    ds_read_b64 v[60:61], v6 offset:1536
    ds_read_b64 v[62:63], v6 offset:1544
    ds_read_b128 v[96:99], v7 offset:1536
    ds_read_b64 v[56:57], v6 offset:1024
    ds_read_b64 v[58:59], v6 offset:1032
    ds_read_b128 v[100:103], v7 offset:1024
    ds_read_b64 v[52:53], v6 offset:512
    ds_read_b64 v[54:55], v6 offset:520
    ds_read_b128 v[104:107], v7 offset:512
    ds_read_b64 v[48:49], v6 offset:0
    ds_read_b64 v[50:51], v6 offset:8
    ds_read_b128 v[108:111], v7 offset:0
    s_waitcnt lgkmcnt(15)
    v_mfma_f32_16x16x32_bf16 v[44:47], v[76:79], v[80:83], v[44:47]
    ds_read_b64 v[76:77], v6 offset:3648
    ds_read_b64 v[78:79], v6 offset:3656
    s_waitcnt lgkmcnt(15)
    v_mfma_f32_16x16x32_bf16 v[40:43], v[72:75], v[80:83], v[40:43]
    v_mfma_f32_16x16x32_bf16 v[44:47], v[72:75], v[84:87], v[44:47]
    ds_read_b64 v[72:73], v6 offset:3136
    ds_read_b64 v[74:75], v6 offset:3144
    s_waitcnt lgkmcnt(15)
    v_mfma_f32_16x16x32_bf16 v[36:39], v[68:71], v[80:83], v[36:39]
    v_mfma_f32_16x16x32_bf16 v[40:43], v[68:71], v[84:87], v[40:43]
    v_mfma_f32_16x16x32_bf16 v[44:47], v[68:71], v[88:91], v[44:47]
    ds_read_b64 v[68:69], v6 offset:2624
    ds_read_b64 v[70:71], v6 offset:2632
    s_waitcnt lgkmcnt(15)
    v_mfma_f32_16x16x32_bf16 v[32:35], v[64:67], v[80:83], v[32:35]
    v_mfma_f32_16x16x32_bf16 v[36:39], v[64:67], v[84:87], v[36:39]
    v_mfma_f32_16x16x32_bf16 v[40:43], v[64:67], v[88:91], v[40:43]
    v_mfma_f32_16x16x32_bf16 v[44:47], v[64:67], v[92:95], v[44:47]
    ds_read_b64 v[64:65], v6 offset:2112
    ds_read_b64 v[66:67], v6 offset:2120
    s_waitcnt lgkmcnt(15)
    v_mfma_f32_16x16x32_bf16 v[28:31], v[60:63], v[80:83], v[28:31]
    v_mfma_f32_16x16x32_bf16 v[32:35], v[60:63], v[84:87], v[32:35]
    v_mfma_f32_16x16x32_bf16 v[36:39], v[60:63], v[88:91], v[36:39]
    v_mfma_f32_16x16x32_bf16 v[40:43], v[60:63], v[92:95], v[40:43]
    v_mfma_f32_16x16x32_bf16 v[44:47], v[60:63], v[96:99], v[44:47]
    ds_read_b64 v[60:61], v6 offset:1600
    ds_read_b64 v[62:63], v6 offset:1608
    s_waitcnt lgkmcnt(15)
    v_mfma_f32_16x16x32_bf16 v[24:27], v[56:59], v[80:83], v[24:27]
    v_mfma_f32_16x16x32_bf16 v[28:31], v[56:59], v[84:87], v[28:31]
    v_mfma_f32_16x16x32_bf16 v[32:35], v[56:59], v[88:91], v[32:35]
    v_mfma_f32_16x16x32_bf16 v[36:39], v[56:59], v[92:95], v[36:39]
    v_mfma_f32_16x16x32_bf16 v[40:43], v[56:59], v[96:99], v[40:43]
    v_mfma_f32_16x16x32_bf16 v[44:47], v[56:59], v[100:103], v[44:47]
    ds_read_b64 v[56:57], v6 offset:1088
    ds_read_b64 v[58:59], v6 offset:1096
    s_waitcnt lgkmcnt(15)
    v_mfma_f32_16x16x32_bf16 v[20:23], v[52:55], v[80:83], v[20:23]
    v_mfma_f32_16x16x32_bf16 v[24:27], v[52:55], v[84:87], v[24:27]
    v_mfma_f32_16x16x32_bf16 v[28:31], v[52:55], v[88:91], v[28:31]
    v_mfma_f32_16x16x32_bf16 v[32:35], v[52:55], v[92:95], v[32:35]
    v_mfma_f32_16x16x32_bf16 v[36:39], v[52:55], v[96:99], v[36:39]
    v_mfma_f32_16x16x32_bf16 v[40:43], v[52:55], v[100:103], v[40:43]
    v_mfma_f32_16x16x32_bf16 v[44:47], v[52:55], v[104:107], v[44:47]
    ds_read_b64 v[52:53], v6 offset:576
    ds_read_b64 v[54:55], v6 offset:584
    s_waitcnt lgkmcnt(14)
    s_cmp_lg_u32 s32, 0
    s_cbranch_scc1 K2C_ND1
    v_mfma_f32_16x16x32_bf16 v[16:19], v[112:115], v[80:83], v[16:19]
    v_mfma_f32_16x16x32_bf16 v[20:23], v[112:115], v[84:87], v[20:23]
    v_mfma_f32_16x16x32_bf16 v[24:27], v[112:115], v[88:91], v[24:27]
    v_mfma_f32_16x16x32_bf16 v[28:31], v[112:115], v[92:95], v[28:31]
    v_mfma_f32_16x16x32_bf16 v[32:35], v[112:115], v[96:99], v[32:35]
    v_mfma_f32_16x16x32_bf16 v[36:39], v[112:115], v[100:103], v[36:39]
    v_mfma_f32_16x16x32_bf16 v[40:43], v[112:115], v[104:107], v[40:43]
    v_mfma_f32_16x16x32_bf16 v[44:47], v[112:115], v[108:111], v[44:47]
K2C_ND1:
    v_mfma_f32_16x16x32_bf16 v[16:19], v[48:51], v[80:83], v[16:19]
    ds_read_b128 v[80:83], v7 offset:3648
    v_mfma_f32_16x16x32_bf16 v[20:23], v[48:51], v[84:87], v[20:23]
    ds_read_b128 v[84:87], v7 offset:3136
    v_mfma_f32_16x16x32_bf16 v[24:27], v[48:51], v[88:91], v[24:27]
    ds_read_b128 v[88:91], v7 offset:2624
    v_mfma_f32_16x16x32_bf16 v[28:31], v[48:51], v[92:95], v[28:31]
    ds_read_b128 v[92:95], v7 offset:2112
    v_mfma_f32_16x16x32_bf16 v[32:35], v[48:51], v[96:99], v[32:35]
    ds_read_b128 v[96:99], v7 offset:1600
    v_mfma_f32_16x16x32_bf16 v[36:39], v[48:51], v[100:103], v[36:39]
    ds_read_b128 v[100:103], v7 offset:1088
    v_mfma_f32_16x16x32_bf16 v[40:43], v[48:51], v[104:107], v[40:43]
    ds_read_b128 v[104:107], v7 offset:576
    v_mfma_f32_16x16x32_bf16 v[44:47], v[48:51], v[108:111], v[44:47]
    ds_read_b128 v[108:111], v7 offset:64
    ds_read_b64 v[48:49], v6 offset:64
    ds_read_b64 v[50:51], v6 offset:72
    s_waitcnt lgkmcnt(9)
    v_mfma_f32_16x16x32_bf16 v[44:47], v[76:79], v[80:83], v[44:47]
    s_waitcnt lgkmcnt(8)
    v_mfma_f32_16x16x32_bf16 v[40:43], v[72:75], v[80:83], v[40:43]
    v_mfma_f32_16x16x32_bf16 v[44:47], v[72:75], v[84:87], v[44:47]
    s_waitcnt lgkmcnt(7)
    v_mfma_f32_16x16x32_bf16 v[36:39], v[68:71], v[80:83], v[36:39]
    v_mfma_f32_16x16x32_bf16 v[40:43], v[68:71], v[84:87], v[40:43]
    v_mfma_f32_16x16x32_bf16 v[44:47], v[68:71], v[88:91], v[44:47]
    s_waitcnt lgkmcnt(6)
    v_mfma_f32_16x16x32_bf16 v[32:35], v[64:67], v[80:83], v[32:35]
    v_mfma_f32_16x16x32_bf16 v[36:39], v[64:67], v[84:87], v[36:39]
    v_mfma_f32_16x16x32_bf16 v[40:43], v[64:67], v[88:91], v[40:43]
    v_mfma_f32_16x16x32_bf16 v[44:47], v[64:67], v[92:95], v[44:47]
    s_waitcnt lgkmcnt(5)
    v_mfma_f32_16x16x32_bf16 v[28:31], v[60:63], v[80:83], v[28:31]
    v_mfma_f32_16x16x32_bf16 v[32:35], v[60:63], v[84:87], v[32:35]
    v_mfma_f32_16x16x32_bf16 v[36:39], v[60:63], v[88:91], v[36:39]
    v_mfma_f32_16x16x32_bf16 v[40:43], v[60:63], v[92:95], v[40:43]
    v_mfma_f32_16x16x32_bf16 v[44:47], v[60:63], v[96:99], v[44:47]
    s_waitcnt lgkmcnt(4)
    v_mfma_f32_16x16x32_bf16 v[24:27], v[56:59], v[80:83], v[24:27]
    v_mfma_f32_16x16x32_bf16 v[28:31], v[56:59], v[84:87], v[28:31]
    v_mfma_f32_16x16x32_bf16 v[32:35], v[56:59], v[88:91], v[32:35]
    v_mfma_f32_16x16x32_bf16 v[36:39], v[56:59], v[92:95], v[36:39]
    v_mfma_f32_16x16x32_bf16 v[40:43], v[56:59], v[96:99], v[40:43]
    v_mfma_f32_16x16x32_bf16 v[44:47], v[56:59], v[100:103], v[44:47]
    s_waitcnt lgkmcnt(3)
    v_mfma_f32_16x16x32_bf16 v[20:23], v[52:55], v[80:83], v[20:23]
    v_mfma_f32_16x16x32_bf16 v[24:27], v[52:55], v[84:87], v[24:27]
    v_mfma_f32_16x16x32_bf16 v[28:31], v[52:55], v[88:91], v[28:31]
    v_mfma_f32_16x16x32_bf16 v[32:35], v[52:55], v[92:95], v[32:35]
    v_mfma_f32_16x16x32_bf16 v[36:39], v[52:55], v[96:99], v[36:39]
    v_mfma_f32_16x16x32_bf16 v[40:43], v[52:55], v[100:103], v[40:43]
    v_mfma_f32_16x16x32_bf16 v[44:47], v[52:55], v[104:107], v[44:47]
    s_waitcnt lgkmcnt(0)
    s_barrier
    v_mfma_f32_16x16x32_bf16 v[16:19], v[48:51], v[80:83], v[16:19]
    v_mfma_f32_16x16x32_bf16 v[20:23], v[48:51], v[84:87], v[20:23]
    v_mfma_f32_16x16x32_bf16 v[24:27], v[48:51], v[88:91], v[24:27]
    v_mfma_f32_16x16x32_bf16 v[28:31], v[48:51], v[92:95], v[28:31]
    v_mfma_f32_16x16x32_bf16 v[32:35], v[48:51], v[96:99], v[32:35]
    v_mfma_f32_16x16x32_bf16 v[36:39], v[48:51], v[100:103], v[36:39]
    v_mfma_f32_16x16x32_bf16 v[40:43], v[48:51], v[104:107], v[40:43]
    v_mfma_f32_16x16x32_bf16 v[44:47], v[48:51], v[108:111], v[44:47]
    v_lshlrev_b32 v3, 4, v0
    s_lshl_b32 s37, s3, 13
    v_add_u32 v4, s37, v3
    ds_write_b128 v4, v[16:19] offset:0
    ds_write_b128 v4, v[20:23] offset:1024
    ds_write_b128 v4, v[24:27] offset:2048
    ds_write_b128 v4, v[28:31] offset:3072
    ds_write_b128 v4, v[32:35] offset:4096
    ds_write_b128 v4, v[36:39] offset:5120
    ds_write_b128 v4, v[40:43] offset:6144
    ds_write_b128 v4, v[44:47] offset:7168
    s_lshl_b32 s37, s3, 11
    v_add_u32 v4, s37, v3
    s_waitcnt lgkmcnt(0)
    s_barrier
    ds_read_b128 v[48:51], v4 offset:0
    ds_read_b128 v[52:55], v4 offset:8192
    ds_read_b128 v[56:59], v4 offset:16384
    ds_read_b128 v[60:63], v4 offset:24576
    ds_read_b128 v[64:67], v4 offset:1024
    ds_read_b128 v[68:71], v4 offset:9216
    ds_read_b128 v[72:75], v4 offset:17408
    ds_read_b128 v[76:79], v4 offset:25600
    v_lshrrev_b32 v5, 1, v1
    v_lshlrev_b32 v5, 6, v5
    v_and_b32 v8, 1, v1
    v_lshlrev_b32 v8, 3, v8
    v_lshlrev_b32 v9, 4, v2
    v_add3_u32 v5, v5, v8, v9
    s_mul_i32 s37, s32, 1024
    v_add_u32 v5, s37, v5
    s_waitcnt lgkmcnt(4)
    v_add_f32 v48, v48, v52
    v_add_f32 v49, v49, v53
    v_add_f32 v50, v50, v54
    v_add_f32 v51, v51, v55
    v_add_f32 v48, v48, v56
    v_add_f32 v49, v49, v57
    v_add_f32 v50, v50, v58
    v_add_f32 v51, v51, v59
    v_add_f32 v48, v48, v60
    v_add_f32 v49, v49, v61
    v_add_f32 v50, v50, v62
    v_add_f32 v51, v51, v63
    v_cvt_pk_bf16_f32 v10, v48, v49
    v_cvt_pk_bf16_f32 v11, v50, v51
    buffer_store_dwordx2 v[10:11], v5, s[28:31], 0 offen offset:0 sc1
    s_waitcnt lgkmcnt(0)
    v_add_f32 v64, v64, v68
    v_add_f32 v65, v65, v69
    v_add_f32 v66, v66, v70
    v_add_f32 v67, v67, v71
    v_add_f32 v64, v64, v72
    v_add_f32 v65, v65, v73
    v_add_f32 v66, v66, v74
    v_add_f32 v67, v67, v75
    v_add_f32 v64, v64, v76
    v_add_f32 v65, v65, v77
    v_add_f32 v66, v66, v78
    v_add_f32 v67, v67, v79
    v_cvt_pk_bf16_f32 v12, v64, v65
    v_cvt_pk_bf16_f32 v13, v66, v67
    buffer_store_dwordx2 v[12:13], v5, s[28:31], 0 offen offset:512 sc1
    s_branch K2_END
K2_AUX:
    s_sub_u32 s16, s2, 896
    s_lshl_b32 s16, s16, 2
    s_add_u32 s16, s16, s3
    s_waitcnt lgkmcnt(0)
    s_mov_b32 s32, s10
    s_mov_b32 s33, s11
    s_mov_b32 s34, 0xc8000
    s_mov_b32 s35, 0x20000
    s_add_u32 s36, s4, 0x1180000
    s_addc_u32 s37, s5, 0
    s_mov_b32 s38, 0xc8000
    s_mov_b32 s39, 0x20000
    s_mov_b32 s40, s12
    s_mov_b32 s41, s13
    s_mov_b32 s42, 0x280000
    s_mov_b32 s43, 0x20000
    s_lshl_b32 s30, s16, 2
    s_and_b32 s31, s30, 0xfffffff3
    s_and_b32 s50, s30, 4
    s_lshl_b32 s50, s50, 1
    s_or_b32 s31, s31, s50
    s_and_b32 s50, s30, 8
    s_lshr_b32 s50, s50, 1
    s_or_b32 s31, s31, s50
    s_mul_i32 s30, s30, 1280
    s_mul_i32 s31, s31, 160
    s_movk_i32 s50, 820
    s_movk_i32 s51, 6554
    s_mov_b32 s52, 102400
    v_add_u32 v20, 0, v0
    v_mul_u32_u24 v21, s50, v20
    v_lshrrev_b32 v21, 16, v21
    v_mul_u32_u24 v22, 80, v21
    v_sub_u32 v22, v20, v22
    v_mul_u32_u24 v23, s51, v22
    v_lshrrev_b32 v23, 16, v23
    v_mul_u32_u24 v24, 10, v23
    v_sub_u32 v24, v22, v24
    v_mul_u32_u24 v25, 0x500, v21
    v_lshl_add_u32 v30, v22, 4, v25
    buffer_load_dwordx4 v[64:67], v30, s[32:35], s30 offen
    v_mul_u32_u24 v25, 160, v21
    v_lshl_add_u32 v25, v24, 4, v25
    v_mad_u32_u24 v40, v23, s52, v25
    v_add_u32 v20, 64, v0
    v_mul_u32_u24 v21, s50, v20
    v_lshrrev_b32 v21, 16, v21
    v_mul_u32_u24 v22, 80, v21
    v_sub_u32 v22, v20, v22
    v_mul_u32_u24 v23, s51, v22
    v_lshrrev_b32 v23, 16, v23
    v_mul_u32_u24 v24, 10, v23
    v_sub_u32 v24, v22, v24
    v_mul_u32_u24 v25, 0x500, v21
    v_lshl_add_u32 v30, v22, 4, v25
    buffer_load_dwordx4 v[68:71], v30, s[32:35], s30 offen
    v_mul_u32_u24 v25, 160, v21
    v_lshl_add_u32 v25, v24, 4, v25
    v_mad_u32_u24 v41, v23, s52, v25
    v_add_u32 v20, 128, v0
    v_mul_u32_u24 v21, s50, v20
    v_lshrrev_b32 v21, 16, v21
    v_mul_u32_u24 v22, 80, v21
    v_sub_u32 v22, v20, v22
    v_mul_u32_u24 v23, s51, v22
    v_lshrrev_b32 v23, 16, v23
    v_mul_u32_u24 v24, 10, v23
    v_sub_u32 v24, v22, v24
    v_mul_u32_u24 v25, 0x500, v21
    v_lshl_add_u32 v30, v22, 4, v25
    buffer_load_dwordx4 v[72:75], v30, s[32:35], s30 offen
    v_mul_u32_u24 v25, 160, v21
    v_lshl_add_u32 v25, v24, 4, v25
    v_mad_u32_u24 v42, v23, s52, v25
    v_add_u32 v20, 192, v0
    v_mul_u32_u24 v21, s50, v20
    v_lshrrev_b32 v21, 16, v21
    v_mul_u32_u24 v22, 80, v21
    v_sub_u32 v22, v20, v22
    v_mul_u32_u24 v23, s51, v22
    v_lshrrev_b32 v23, 16, v23
    v_mul_u32_u24 v24, 10, v23
    v_sub_u32 v24, v22, v24
    v_mul_u32_u24 v25, 0x500, v21
    v_lshl_add_u32 v30, v22, 4, v25
    buffer_load_dwordx4 v[76:79], v30, s[32:35], s30 offen
    v_mul_u32_u24 v25, 160, v21
    v_lshl_add_u32 v25, v24, 4, v25
    v_mad_u32_u24 v43, v23, s52, v25
    v_add_u32 v20, 256, v0
    v_mul_u32_u24 v21, s50, v20
    v_lshrrev_b32 v21, 16, v21
    v_mul_u32_u24 v22, 80, v21
    v_sub_u32 v22, v20, v22
    v_mul_u32_u24 v23, s51, v22
    v_lshrrev_b32 v23, 16, v23
    v_mul_u32_u24 v24, 10, v23
    v_sub_u32 v24, v22, v24
    v_mul_u32_u24 v25, 0x500, v21
    v_lshl_add_u32 v30, v22, 4, v25
    buffer_load_dwordx4 v[80:83], v30, s[32:35], s30 offen
    v_mul_u32_u24 v25, 160, v21
    v_lshl_add_u32 v25, v24, 4, v25
    v_mad_u32_u24 v44, v23, s52, v25
    v_lshlrev_b32 v18, 4, v0
    s_lshl_b32 s53, s16, 14
    buffer_load_dwordx4 v[96:99], v18, s[40:43], s53 offen offset:0
    buffer_load_dwordx4 v[100:103], v18, s[40:43], s53 offen offset:1024
    buffer_load_dwordx4 v[104:107], v18, s[40:43], s53 offen offset:2048
    buffer_load_dwordx4 v[108:111], v18, s[40:43], s53 offen offset:3072
    s_add_u32 s53, s53, 4096
    buffer_load_dwordx4 v[96:99], v18, s[40:43], s53 offen offset:0
    buffer_load_dwordx4 v[100:103], v18, s[40:43], s53 offen offset:1024
    buffer_load_dwordx4 v[104:107], v18, s[40:43], s53 offen offset:2048
    buffer_load_dwordx4 v[108:111], v18, s[40:43], s53 offen offset:3072
    s_add_u32 s53, s53, 4096
    buffer_load_dwordx4 v[96:99], v18, s[40:43], s53 offen offset:0
    buffer_load_dwordx4 v[100:103], v18, s[40:43], s53 offen offset:1024
    buffer_load_dwordx4 v[104:107], v18, s[40:43], s53 offen offset:2048
    buffer_load_dwordx4 v[108:111], v18, s[40:43], s53 offen offset:3072
    s_add_u32 s53, s53, 4096
    buffer_load_dwordx4 v[96:99], v18, s[40:43], s53 offen offset:0
    buffer_load_dwordx4 v[100:103], v18, s[40:43], s53 offen offset:1024
    buffer_load_dwordx4 v[104:107], v18, s[40:43], s53 offen offset:2048
    buffer_load_dwordx4 v[108:111], v18, s[40:43], s53 offen offset:3072
    s_waitcnt vmcnt(16)
    buffer_store_dwordx4 v[64:67], v40, s[36:39], s31 offen sc1
    buffer_store_dwordx4 v[68:71], v41, s[36:39], s31 offen sc1
    buffer_store_dwordx4 v[72:75], v42, s[36:39], s31 offen sc1
    buffer_store_dwordx4 v[76:79], v43, s[36:39], s31 offen sc1
    buffer_store_dwordx4 v[80:83], v44, s[36:39], s31 offen sc1
    s_branch K2_EXIT
K2_END:
K2_EXIT:
    s_endpgm
.globl k3_kernel
.p2align 8
.type k3_kernel,@function
k3_kernel:
    s_cmp_ge_u32 s2, 256
    s_cbranch_scc1 K3_EXIT
    s_load_dwordx2 s[4:5], s[0:1], 88
    s_load_dwordx2 s[8:9], s[0:1], 0
    s_load_dwordx2 s[10:11], s[0:1], 72
    v_lshrrev_b32 v1, 6, v0
    v_and_b32 v0, 63, v0
    v_readfirstlane_b32 s3, v1
    s_and_b32 s16, s2, 7
    s_lshl_b32 s16, s16, 2
    s_lshr_b32 s17, s2, 3
    s_and_b32 s18, s17, 3
    s_add_u32 s16, s16, s18
    s_lshr_b32 s17, s2, 5
    s_lshl_b32 s16, s16, 6
    s_mul_i32 s18, s17, 160
    s_cmp_ge_u32 s3, 4
    s_cbranch_scc1 K3_FINAL
    s_lshr_b32 s19, s3, 1
    s_and_b32 s36, s3, 1
    v_lshlrev_b32 v216, 4, v0
    s_mul_i32 s37, s3, 25600
    s_mul_i32 s38, s17, 102400
    s_add_u32 s38, s38, s37
    s_waitcnt lgkmcnt(0)
    s_add_u32 s24, s4, 0x1180000
    s_addc_u32 s25, s5, 0
    s_mov_b32 s26, 0xc8000
    s_mov_b32 s27, 0x20000
    s_add_u32 s20, s4, 0x780000
    s_addc_u32 s21, s5, 0
    s_mov_b32 s22, 0x280000
    s_mov_b32 s23, 0x20000
    s_mov_b32 s40, s10
    s_mov_b32 s41, s11
    s_mov_b32 s42, 0x500000
    s_mov_b32 s43, 0x20000
    v_and_b32 v1, 15, v0
    v_lshrrev_b32 v2, 4, v0
    s_lshl_b32 s47, s36, 5
    s_add_u32 s47, s47, s16
    s_lshr_b32 s48, s47, 4
    s_mul_i32 s48, s48, 20
    s_mul_i32 s39, s19, 10
    s_add_u32 s48, s48, s39
    s_lshl_b32 s48, s48, 10
    v_lshlrev_b32 v6, 4, v0
    v_add_u32 v6, s48, v6
    v_add_u32 v7, 0x5000, v6
    s_mov_b32 s44, 4096
    s_mov_b32 s46, 8192
    s_add_u32 m0, s37, 0
    s_add_u32 s39, s38, 0
    buffer_load_dwordx4 v216, s[24:27], s39 offen offset:0 lds
    buffer_load_dwordx4 v216, s[24:27], s39 offen offset:1024 lds
    buffer_load_dwordx4 v216, s[24:27], s39 offen offset:2048 lds
    buffer_load_dwordx4 v216, s[24:27], s39 offen offset:3072 lds
    s_add_u32 m0, s37, 4096
    s_add_u32 s39, s38, 4096
    buffer_load_dwordx4 v216, s[24:27], s39 offen offset:0 lds
    buffer_load_dwordx4 v216, s[24:27], s39 offen offset:1024 lds
    buffer_load_dwordx4 v216, s[24:27], s39 offen offset:2048 lds
    buffer_load_dwordx4 v216, s[24:27], s39 offen offset:3072 lds
    s_add_u32 m0, s37, 8192
    s_add_u32 s39, s38, 8192
    buffer_load_dwordx4 v216, s[24:27], s39 offen offset:0 lds
    buffer_load_dwordx4 v216, s[24:27], s39 offen offset:1024 lds
    buffer_load_dwordx4 v216, s[24:27], s39 offen offset:2048 lds
    buffer_load_dwordx4 v216, s[24:27], s39 offen offset:3072 lds
    s_add_u32 m0, s37, 12288
    s_add_u32 s39, s38, 12288
    buffer_load_dwordx4 v216, s[24:27], s39 offen offset:0 lds
    buffer_load_dwordx4 v216, s[24:27], s39 offen offset:1024 lds
    buffer_load_dwordx4 v216, s[24:27], s39 offen offset:2048 lds
    buffer_load_dwordx4 v[16:19], v6, s[20:23], 0 offen offset:0
    buffer_load_dwordx4 v[20:23], v7, s[20:23], 0 offen offset:0
    buffer_load_dwordx4 v[24:27], v6, s[20:23], 0 offen offset:1024
    buffer_load_dwordx4 v[28:31], v7, s[20:23], 0 offen offset:1024
    buffer_load_dwordx4 v[32:35], v6, s[20:23], 0 offen offset:2048
    buffer_load_dwordx4 v[36:39], v7, s[20:23], 0 offen offset:2048
    buffer_load_dwordx4 v[56:59], v6, s[20:23], s44 offen offset:1024
    buffer_load_dwordx4 v[60:63], v7, s[20:23], s44 offen offset:1024
    buffer_load_dwordx4 v[64:67], v6, s[20:23], s44 offen offset:2048
    buffer_load_dwordx4 v[68:71], v7, s[20:23], s44 offen offset:2048
    buffer_load_dwordx4 v[72:75], v6, s[20:23], s44 offen offset:3072
    buffer_load_dwordx4 v[76:79], v7, s[20:23], s44 offen offset:3072
    s_mov_b32 s37, s47
    v_lshrrev_b32 v8, 1, v2
    v_lshlrev_b32 v8, 4, v8
    v_and_b32 v9, 1, v2
    v_lshlrev_b32 v9, 2, v9
    v_lshrrev_b32 v10, 2, v0
    v_and_b32 v10, 3, v10
    v_add3_u32 v8, v8, v9, v10
    s_mul_i32 s38, s19, 320
    v_add_u32 v8, s38, v8
    v_mul_u32_u24 v8, 160, v8
    v_and_b32 v9, 3, v0
    v_lshl_add_u32 v8, v9, 3, v8
    v_mov_b32 v96, 0
    v_mov_b32 v97, 0
    v_mov_b32 v98, 0
    v_mov_b32 v99, 0
    v_mov_b32 v100, 0
    v_mov_b32 v101, 0
    v_mov_b32 v102, 0
    v_mov_b32 v103, 0
    v_mov_b32 v104, 0
    v_mov_b32 v105, 0
    v_mov_b32 v106, 0
    v_mov_b32 v107, 0
    v_mov_b32 v108, 0
    v_mov_b32 v109, 0
    v_mov_b32 v110, 0
    v_mov_b32 v111, 0
    v_mov_b32 v112, 0
    v_mov_b32 v113, 0
    v_mov_b32 v114, 0
    v_mov_b32 v115, 0
    v_mov_b32 v116, 0
    v_mov_b32 v117, 0
    v_mov_b32 v118, 0
    v_mov_b32 v119, 0
    v_mov_b32 v120, 0
    v_mov_b32 v121, 0
    v_mov_b32 v122, 0
    v_mov_b32 v123, 0
    v_mov_b32 v124, 0
    v_mov_b32 v125, 0
    v_mov_b32 v126, 0
    v_mov_b32 v127, 0
    v_mov_b32 v128, 0
    v_mov_b32 v129, 0
    v_mov_b32 v130, 0
    v_mov_b32 v131, 0
    v_mov_b32 v132, 0
    v_mov_b32 v133, 0
    v_mov_b32 v134, 0
    v_mov_b32 v135, 0
    s_waitcnt vmcnt(12)
    s_barrier
    buffer_load_dwordx4 v[40:43], v6, s[20:23], 0 offen offset:3072
    buffer_load_dwordx4 v[44:47], v7, s[20:23], 0 offen offset:3072
    buffer_load_dwordx4 v[48:51], v6, s[20:23], s44 offen offset:0
    buffer_load_dwordx4 v[52:55], v7, s[20:23], s44 offen offset:0
    buffer_load_dwordx4 v[80:83], v6, s[20:23], s46 offen offset:0
    buffer_load_dwordx4 v[84:87], v7, s[20:23], s46 offen offset:0
    buffer_load_dwordx4 v[88:91], v6, s[20:23], s46 offen offset:1024
    buffer_load_dwordx4 v[92:95], v7, s[20:23], s46 offen offset:1024
    ds_read_b64_tr_b16 v[136:137], v8 offset:0
    ds_read_b64_tr_b16 v[138:139], v8 offset:1280
    ds_read_b64_tr_b16 v[140:141], v8 offset:32
    ds_read_b64_tr_b16 v[142:143], v8 offset:1312
    ds_read_b64_tr_b16 v[144:145], v8 offset:64
    ds_read_b64_tr_b16 v[146:147], v8 offset:1344
    ds_read_b64_tr_b16 v[148:149], v8 offset:96
    ds_read_b64_tr_b16 v[150:151], v8 offset:1376
    ds_read_b64_tr_b16 v[152:153], v8 offset:128
    ds_read_b64_tr_b16 v[154:155], v8 offset:1408
    s_waitcnt vmcnt(18)
    s_waitcnt lgkmcnt(0)
    v_mfma_f32_16x16x32_bf16 v[96:99], v[136:139], v[16:19], v[96:99]
    ds_read_b64_tr_b16 v[156:157], v8 offset:5120
    v_mfma_f32_16x16x32_bf16 v[100:103], v[136:139], v[20:23], v[100:103]
    ds_read_b64_tr_b16 v[158:159], v8 offset:6400
    v_mfma_f32_16x16x32_bf16 v[104:107], v[140:143], v[16:19], v[104:107]
    ds_read_b64_tr_b16 v[160:161], v8 offset:5152
    v_mfma_f32_16x16x32_bf16 v[108:111], v[140:143], v[20:23], v[108:111]
    ds_read_b64_tr_b16 v[162:163], v8 offset:6432
    v_mfma_f32_16x16x32_bf16 v[112:115], v[144:147], v[16:19], v[112:115]
    ds_read_b64_tr_b16 v[164:165], v8 offset:5184
    v_mfma_f32_16x16x32_bf16 v[116:119], v[144:147], v[20:23], v[116:119]
    ds_read_b64_tr_b16 v[166:167], v8 offset:6464
    v_mfma_f32_16x16x32_bf16 v[120:123], v[148:151], v[16:19], v[120:123]
    ds_read_b64_tr_b16 v[168:169], v8 offset:5216
    v_mfma_f32_16x16x32_bf16 v[124:127], v[148:151], v[20:23], v[124:127]
    ds_read_b64_tr_b16 v[170:171], v8 offset:6496
    v_mfma_f32_16x16x32_bf16 v[128:131], v[152:155], v[16:19], v[128:131]
    ds_read_b64_tr_b16 v[172:173], v8 offset:5248
    v_mfma_f32_16x16x32_bf16 v[132:135], v[152:155], v[20:23], v[132:135]
    ds_read_b64_tr_b16 v[174:175], v8 offset:6528
    s_waitcnt vmcnt(16)
    s_waitcnt lgkmcnt(0)
    v_mfma_f32_16x16x32_bf16 v[96:99], v[156:159], v[24:27], v[96:99]
    ds_read_b64_tr_b16 v[136:137], v8 offset:10240
    v_mfma_f32_16x16x32_bf16 v[100:103], v[156:159], v[28:31], v[100:103]
    ds_read_b64_tr_b16 v[138:139], v8 offset:11520
    v_mfma_f32_16x16x32_bf16 v[104:107], v[160:163], v[24:27], v[104:107]
    ds_read_b64_tr_b16 v[140:141], v8 offset:10272
    v_mfma_f32_16x16x32_bf16 v[108:111], v[160:163], v[28:31], v[108:111]
    ds_read_b64_tr_b16 v[142:143], v8 offset:11552
    v_mfma_f32_16x16x32_bf16 v[112:115], v[164:167], v[24:27], v[112:115]
    ds_read_b64_tr_b16 v[144:145], v8 offset:10304
    v_mfma_f32_16x16x32_bf16 v[116:119], v[164:167], v[28:31], v[116:119]
    ds_read_b64_tr_b16 v[146:147], v8 offset:11584
    v_mfma_f32_16x16x32_bf16 v[120:123], v[168:171], v[24:27], v[120:123]
    ds_read_b64_tr_b16 v[148:149], v8 offset:10336
    v_mfma_f32_16x16x32_bf16 v[124:127], v[168:171], v[28:31], v[124:127]
    ds_read_b64_tr_b16 v[150:151], v8 offset:11616
    v_mfma_f32_16x16x32_bf16 v[128:131], v[172:175], v[24:27], v[128:131]
    ds_read_b64_tr_b16 v[152:153], v8 offset:10368
    v_mfma_f32_16x16x32_bf16 v[132:135], v[172:175], v[28:31], v[132:135]
    ds_read_b64_tr_b16 v[154:155], v8 offset:11648
    s_waitcnt vmcnt(14)
    s_waitcnt lgkmcnt(0)
    v_mfma_f32_16x16x32_bf16 v[96:99], v[136:139], v[32:35], v[96:99]
    ds_read_b64_tr_b16 v[156:157], v8 offset:25600
    v_mfma_f32_16x16x32_bf16 v[100:103], v[136:139], v[36:39], v[100:103]
    ds_read_b64_tr_b16 v[158:159], v8 offset:26880
    v_mfma_f32_16x16x32_bf16 v[104:107], v[140:143], v[32:35], v[104:107]
    ds_read_b64_tr_b16 v[160:161], v8 offset:25632
    v_mfma_f32_16x16x32_bf16 v[108:111], v[140:143], v[36:39], v[108:111]
    ds_read_b64_tr_b16 v[162:163], v8 offset:26912
    v_mfma_f32_16x16x32_bf16 v[112:115], v[144:147], v[32:35], v[112:115]
    ds_read_b64_tr_b16 v[164:165], v8 offset:25664
    v_mfma_f32_16x16x32_bf16 v[116:119], v[144:147], v[36:39], v[116:119]
    ds_read_b64_tr_b16 v[166:167], v8 offset:26944
    v_mfma_f32_16x16x32_bf16 v[120:123], v[148:151], v[32:35], v[120:123]
    ds_read_b64_tr_b16 v[168:169], v8 offset:25696
    v_mfma_f32_16x16x32_bf16 v[124:127], v[148:151], v[36:39], v[124:127]
    ds_read_b64_tr_b16 v[170:171], v8 offset:26976
    v_mfma_f32_16x16x32_bf16 v[128:131], v[152:155], v[32:35], v[128:131]
    ds_read_b64_tr_b16 v[172:173], v8 offset:25728
    v_mfma_f32_16x16x32_bf16 v[132:135], v[152:155], v[36:39], v[132:135]
    ds_read_b64_tr_b16 v[174:175], v8 offset:27008
    s_waitcnt vmcnt(12)
    s_waitcnt lgkmcnt(0)
    v_mfma_f32_16x16x32_bf16 v[96:99], v[156:159], v[56:59], v[96:99]
    ds_read_b64_tr_b16 v[136:137], v8 offset:30720
    v_mfma_f32_16x16x32_bf16 v[100:103], v[156:159], v[60:63], v[100:103]
    ds_read_b64_tr_b16 v[138:139], v8 offset:32000
    v_mfma_f32_16x16x32_bf16 v[104:107], v[160:163], v[56:59], v[104:107]
    ds_read_b64_tr_b16 v[140:141], v8 offset:30752
    v_mfma_f32_16x16x32_bf16 v[108:111], v[160:163], v[60:63], v[108:111]
    ds_read_b64_tr_b16 v[142:143], v8 offset:32032
    v_mfma_f32_16x16x32_bf16 v[112:115], v[164:167], v[56:59], v[112:115]
    ds_read_b64_tr_b16 v[144:145], v8 offset:30784
    v_mfma_f32_16x16x32_bf16 v[116:119], v[164:167], v[60:63], v[116:119]
    ds_read_b64_tr_b16 v[146:147], v8 offset:32064
    v_mfma_f32_16x16x32_bf16 v[120:123], v[168:171], v[56:59], v[120:123]
    ds_read_b64_tr_b16 v[148:149], v8 offset:30816
    v_mfma_f32_16x16x32_bf16 v[124:127], v[168:171], v[60:63], v[124:127]
    ds_read_b64_tr_b16 v[150:151], v8 offset:32096
    v_mfma_f32_16x16x32_bf16 v[128:131], v[172:175], v[56:59], v[128:131]
    ds_read_b64_tr_b16 v[152:153], v8 offset:30848
    v_mfma_f32_16x16x32_bf16 v[132:135], v[172:175], v[60:63], v[132:135]
    ds_read_b64_tr_b16 v[154:155], v8 offset:32128
    s_waitcnt vmcnt(10)
    s_waitcnt lgkmcnt(0)
    v_mfma_f32_16x16x32_bf16 v[96:99], v[136:139], v[64:67], v[96:99]
    ds_read_b64_tr_b16 v[156:157], v8 offset:35840
    v_mfma_f32_16x16x32_bf16 v[100:103], v[136:139], v[68:71], v[100:103]
    ds_read_b64_tr_b16 v[158:159], v8 offset:37120
    v_mfma_f32_16x16x32_bf16 v[104:107], v[140:143], v[64:67], v[104:107]
    ds_read_b64_tr_b16 v[160:161], v8 offset:35872
    v_mfma_f32_16x16x32_bf16 v[108:111], v[140:143], v[68:71], v[108:111]
    ds_read_b64_tr_b16 v[162:163], v8 offset:37152
    v_mfma_f32_16x16x32_bf16 v[112:115], v[144:147], v[64:67], v[112:115]
    ds_read_b64_tr_b16 v[164:165], v8 offset:35904
    v_mfma_f32_16x16x32_bf16 v[116:119], v[144:147], v[68:71], v[116:119]
    ds_read_b64_tr_b16 v[166:167], v8 offset:37184
    v_mfma_f32_16x16x32_bf16 v[120:123], v[148:151], v[64:67], v[120:123]
    ds_read_b64_tr_b16 v[168:169], v8 offset:35936
    v_mfma_f32_16x16x32_bf16 v[124:127], v[148:151], v[68:71], v[124:127]
    ds_read_b64_tr_b16 v[170:171], v8 offset:37216
    v_mfma_f32_16x16x32_bf16 v[128:131], v[152:155], v[64:67], v[128:131]
    ds_read_b64_tr_b16 v[172:173], v8 offset:35968
    v_mfma_f32_16x16x32_bf16 v[132:135], v[152:155], v[68:71], v[132:135]
    ds_read_b64_tr_b16 v[174:175], v8 offset:37248
    s_barrier
    s_waitcnt vmcnt(8)
    s_waitcnt lgkmcnt(0)
    v_mfma_f32_16x16x32_bf16 v[96:99], v[156:159], v[72:75], v[96:99]
    ds_read_b64_tr_b16 v[136:137], v8 offset:15360
    v_mfma_f32_16x16x32_bf16 v[100:103], v[156:159], v[76:79], v[100:103]
    ds_read_b64_tr_b16 v[138:139], v8 offset:16640
    v_mfma_f32_16x16x32_bf16 v[104:107], v[160:163], v[72:75], v[104:107]
    ds_read_b64_tr_b16 v[140:141], v8 offset:15392
    v_mfma_f32_16x16x32_bf16 v[108:111], v[160:163], v[76:79], v[108:111]
    ds_read_b64_tr_b16 v[142:143], v8 offset:16672
    v_mfma_f32_16x16x32_bf16 v[112:115], v[164:167], v[72:75], v[112:115]
    ds_read_b64_tr_b16 v[144:145], v8 offset:15424
    v_mfma_f32_16x16x32_bf16 v[116:119], v[164:167], v[76:79], v[116:119]
    ds_read_b64_tr_b16 v[146:147], v8 offset:16704
    v_mfma_f32_16x16x32_bf16 v[120:123], v[168:171], v[72:75], v[120:123]
    ds_read_b64_tr_b16 v[148:149], v8 offset:15456
    v_mfma_f32_16x16x32_bf16 v[124:127], v[168:171], v[76:79], v[124:127]
    ds_read_b64_tr_b16 v[150:151], v8 offset:16736
    v_mfma_f32_16x16x32_bf16 v[128:131], v[172:175], v[72:75], v[128:131]
    ds_read_b64_tr_b16 v[152:153], v8 offset:15488
    v_mfma_f32_16x16x32_bf16 v[132:135], v[172:175], v[76:79], v[132:135]
    ds_read_b64_tr_b16 v[154:155], v8 offset:16768
    s_waitcnt vmcnt(6)
    s_waitcnt lgkmcnt(0)
    v_mfma_f32_16x16x32_bf16 v[96:99], v[136:139], v[40:43], v[96:99]
    ds_read_b64_tr_b16 v[156:157], v8 offset:20480
    v_mfma_f32_16x16x32_bf16 v[100:103], v[136:139], v[44:47], v[100:103]
    ds_read_b64_tr_b16 v[158:159], v8 offset:21760
    v_mfma_f32_16x16x32_bf16 v[104:107], v[140:143], v[40:43], v[104:107]
    ds_read_b64_tr_b16 v[160:161], v8 offset:20512
    v_mfma_f32_16x16x32_bf16 v[108:111], v[140:143], v[44:47], v[108:111]
    ds_read_b64_tr_b16 v[162:163], v8 offset:21792
    v_mfma_f32_16x16x32_bf16 v[112:115], v[144:147], v[40:43], v[112:115]
    ds_read_b64_tr_b16 v[164:165], v8 offset:20544
    v_mfma_f32_16x16x32_bf16 v[116:119], v[144:147], v[44:47], v[116:119]
    ds_read_b64_tr_b16 v[166:167], v8 offset:21824
    v_mfma_f32_16x16x32_bf16 v[120:123], v[148:151], v[40:43], v[120:123]
    ds_read_b64_tr_b16 v[168:169], v8 offset:20576
    v_mfma_f32_16x16x32_bf16 v[124:127], v[148:151], v[44:47], v[124:127]
    ds_read_b64_tr_b16 v[170:171], v8 offset:21856
    v_mfma_f32_16x16x32_bf16 v[128:131], v[152:155], v[40:43], v[128:131]
    ds_read_b64_tr_b16 v[172:173], v8 offset:20608
    v_mfma_f32_16x16x32_bf16 v[132:135], v[152:155], v[44:47], v[132:135]
    ds_read_b64_tr_b16 v[174:175], v8 offset:21888
    s_waitcnt vmcnt(4)
    s_waitcnt lgkmcnt(0)
    v_mfma_f32_16x16x32_bf16 v[96:99], v[156:159], v[48:51], v[96:99]
    ds_read_b64_tr_b16 v[136:137], v8 offset:40960
    v_mfma_f32_16x16x32_bf16 v[100:103], v[156:159], v[52:55], v[100:103]
    ds_read_b64_tr_b16 v[138:139], v8 offset:42240
    v_mfma_f32_16x16x32_bf16 v[104:107], v[160:163], v[48:51], v[104:107]
    ds_read_b64_tr_b16 v[140:141], v8 offset:40992
    v_mfma_f32_16x16x32_bf16 v[108:111], v[160:163], v[52:55], v[108:111]
    ds_read_b64_tr_b16 v[142:143], v8 offset:42272
    v_mfma_f32_16x16x32_bf16 v[112:115], v[164:167], v[48:51], v[112:115]
    ds_read_b64_tr_b16 v[144:145], v8 offset:41024
    v_mfma_f32_16x16x32_bf16 v[116:119], v[164:167], v[52:55], v[116:119]
    ds_read_b64_tr_b16 v[146:147], v8 offset:42304
    v_mfma_f32_16x16x32_bf16 v[120:123], v[168:171], v[48:51], v[120:123]
    ds_read_b64_tr_b16 v[148:149], v8 offset:41056
    v_mfma_f32_16x16x32_bf16 v[124:127], v[168:171], v[52:55], v[124:127]
    ds_read_b64_tr_b16 v[150:151], v8 offset:42336
    v_mfma_f32_16x16x32_bf16 v[128:131], v[172:175], v[48:51], v[128:131]
    ds_read_b64_tr_b16 v[152:153], v8 offset:41088
    v_mfma_f32_16x16x32_bf16 v[132:135], v[172:175], v[52:55], v[132:135]
    ds_read_b64_tr_b16 v[154:155], v8 offset:42368
    s_waitcnt vmcnt(2)
    s_waitcnt lgkmcnt(0)
    v_mfma_f32_16x16x32_bf16 v[96:99], v[136:139], v[80:83], v[96:99]
    ds_read_b64_tr_b16 v[156:157], v8 offset:46080
    v_mfma_f32_16x16x32_bf16 v[100:103], v[136:139], v[84:87], v[100:103]
    ds_read_b64_tr_b16 v[158:159], v8 offset:47360
    v_mfma_f32_16x16x32_bf16 v[104:107], v[140:143], v[80:83], v[104:107]
    ds_read_b64_tr_b16 v[160:161], v8 offset:46112
    v_mfma_f32_16x16x32_bf16 v[108:111], v[140:143], v[84:87], v[108:111]
    ds_read_b64_tr_b16 v[162:163], v8 offset:47392
    v_mfma_f32_16x16x32_bf16 v[112:115], v[144:147], v[80:83], v[112:115]
    ds_read_b64_tr_b16 v[164:165], v8 offset:46144
    v_mfma_f32_16x16x32_bf16 v[116:119], v[144:147], v[84:87], v[116:119]
    ds_read_b64_tr_b16 v[166:167], v8 offset:47424
    v_mfma_f32_16x16x32_bf16 v[120:123], v[148:151], v[80:83], v[120:123]
    ds_read_b64_tr_b16 v[168:169], v8 offset:46176
    v_mfma_f32_16x16x32_bf16 v[124:127], v[148:151], v[84:87], v[124:127]
    ds_read_b64_tr_b16 v[170:171], v8 offset:47456
    v_mfma_f32_16x16x32_bf16 v[128:131], v[152:155], v[80:83], v[128:131]
    ds_read_b64_tr_b16 v[172:173], v8 offset:46208
    v_mfma_f32_16x16x32_bf16 v[132:135], v[152:155], v[84:87], v[132:135]
    ds_read_b64_tr_b16 v[174:175], v8 offset:47488
    s_waitcnt vmcnt(0)
    s_waitcnt lgkmcnt(0)
    v_mfma_f32_16x16x32_bf16 v[96:99], v[156:159], v[88:91], v[96:99]
    v_mfma_f32_16x16x32_bf16 v[100:103], v[156:159], v[92:95], v[100:103]
    v_mfma_f32_16x16x32_bf16 v[104:107], v[160:163], v[88:91], v[104:107]
    v_mfma_f32_16x16x32_bf16 v[108:111], v[160:163], v[92:95], v[108:111]
    v_mfma_f32_16x16x32_bf16 v[112:115], v[164:167], v[88:91], v[112:115]
    v_mfma_f32_16x16x32_bf16 v[116:119], v[164:167], v[92:95], v[116:119]
    v_mfma_f32_16x16x32_bf16 v[120:123], v[168:171], v[88:91], v[120:123]
    v_mfma_f32_16x16x32_bf16 v[124:127], v[168:171], v[92:95], v[124:127]
    v_mfma_f32_16x16x32_bf16 v[128:131], v[172:175], v[88:91], v[128:131]
    v_mfma_f32_16x16x32_bf16 v[132:135], v[172:175], v[92:95], v[132:135]
    v_lshlrev_b32 v3, 4, v0
    s_mul_i32 s38, s36, 10240
    s_add_u32 s38, s38, 102400
    v_add_u32 v3, s38, v3
    s_cmp_eq_u32 s19, 0
    s_cbranch_scc1 K3_RED0
    s_nop 7
    ds_write_b128 v3, v[96:99] offset:0
    ds_write_b128 v3, v[100:103] offset:1024
    ds_write_b128 v3, v[104:107] offset:2048
    ds_write_b128 v3, v[108:111] offset:3072
    ds_write_b128 v3, v[112:115] offset:4096
    ds_write_b128 v3, v[116:119] offset:5120
    ds_write_b128 v3, v[120:123] offset:6144
    ds_write_b128 v3, v[124:127] offset:7168
    ds_write_b128 v3, v[128:131] offset:8192
    ds_write_b128 v3, v[132:135] offset:9216
    s_waitcnt lgkmcnt(0)
    s_barrier
    s_branch K3_END
K3_RED0:
    v_add_u32 v6, s37, v1
    v_mul_u32_u24 v6, 0xa00, v6
    v_lshl_add_u32 v6, v2, 3, v6
    s_add_u32 s38, s18, 1280
    v_add_u32 v6, s38, v6
    v_add_u32 v7, 0xa000, v6
    s_barrier
    ds_read_b128 v[16:19], v3 offset:0
    ds_read_b128 v[20:23], v3 offset:1024
    ds_read_b128 v[24:27], v3 offset:2048
    ds_read_b128 v[28:31], v3 offset:3072
    ds_read_b128 v[32:35], v3 offset:4096
    ds_read_b128 v[36:39], v3 offset:5120
    ds_read_b128 v[40:43], v3 offset:6144
    ds_read_b128 v[44:47], v3 offset:7168
    ds_read_b128 v[48:51], v3 offset:8192
    ds_read_b128 v[52:55], v3 offset:9216
    s_waitcnt lgkmcnt(9)
    v_add_f32 v96, v96, v16
    v_add_f32 v97, v97, v17
    v_add_f32 v98, v98, v18
    v_add_f32 v99, v99, v19
    v_cvt_pk_bf16_f32 v60, v96, v97
    v_cvt_pk_bf16_f32 v61, v98, v99
    buffer_store_dwordx2 v[60:61], v6, s[40:43], 0 offen offset:0
    s_waitcnt lgkmcnt(8)
    v_add_f32 v100, v100, v20
    v_add_f32 v101, v101, v21
    v_add_f32 v102, v102, v22
    v_add_f32 v103, v103, v23
    v_cvt_pk_bf16_f32 v62, v100, v101
    v_cvt_pk_bf16_f32 v63, v102, v103
    buffer_store_dwordx2 v[62:63], v7, s[40:43], 0 offen offset:0
    s_waitcnt lgkmcnt(7)
    v_add_f32 v104, v104, v24
    v_add_f32 v105, v105, v25
    v_add_f32 v106, v106, v26
    v_add_f32 v107, v107, v27
    v_cvt_pk_bf16_f32 v64, v104, v105
    v_cvt_pk_bf16_f32 v65, v106, v107
    buffer_store_dwordx2 v[64:65], v6, s[40:43], 0 offen offset:32
    s_waitcnt lgkmcnt(6)
    v_add_f32 v108, v108, v28
    v_add_f32 v109, v109, v29
    v_add_f32 v110, v110, v30
    v_add_f32 v111, v111, v31
    v_cvt_pk_bf16_f32 v66, v108, v109
    v_cvt_pk_bf16_f32 v67, v110, v111
    buffer_store_dwordx2 v[66:67], v7, s[40:43], 0 offen offset:32
    s_waitcnt lgkmcnt(5)
    v_add_f32 v112, v112, v32
    v_add_f32 v113, v113, v33
    v_add_f32 v114, v114, v34
    v_add_f32 v115, v115, v35
    v_cvt_pk_bf16_f32 v68, v112, v113
    v_cvt_pk_bf16_f32 v69, v114, v115
    buffer_store_dwordx2 v[68:69], v6, s[40:43], 0 offen offset:64
    s_waitcnt lgkmcnt(4)
    v_add_f32 v116, v116, v36
    v_add_f32 v117, v117, v37
    v_add_f32 v118, v118, v38
    v_add_f32 v119, v119, v39
    v_cvt_pk_bf16_f32 v70, v116, v117
    v_cvt_pk_bf16_f32 v71, v118, v119
    buffer_store_dwordx2 v[70:71], v7, s[40:43], 0 offen offset:64
    s_waitcnt lgkmcnt(3)
    v_add_f32 v120, v120, v40
    v_add_f32 v121, v121, v41
    v_add_f32 v122, v122, v42
    v_add_f32 v123, v123, v43
    v_cvt_pk_bf16_f32 v72, v120, v121
    v_cvt_pk_bf16_f32 v73, v122, v123
    buffer_store_dwordx2 v[72:73], v6, s[40:43], 0 offen offset:96
    s_waitcnt lgkmcnt(2)
    v_add_f32 v124, v124, v44
    v_add_f32 v125, v125, v45
    v_add_f32 v126, v126, v46
    v_add_f32 v127, v127, v47
    v_cvt_pk_bf16_f32 v74, v124, v125
    v_cvt_pk_bf16_f32 v75, v126, v127
    buffer_store_dwordx2 v[74:75], v7, s[40:43], 0 offen offset:96
    s_waitcnt lgkmcnt(1)
    v_add_f32 v128, v128, v48
    v_add_f32 v129, v129, v49
    v_add_f32 v130, v130, v50
    v_add_f32 v131, v131, v51
    v_cvt_pk_bf16_f32 v76, v128, v129
    v_cvt_pk_bf16_f32 v77, v130, v131
    buffer_store_dwordx2 v[76:77], v6, s[40:43], 0 offen offset:128
    s_waitcnt lgkmcnt(0)
    v_add_f32 v132, v132, v52
    v_add_f32 v133, v133, v53
    v_add_f32 v134, v134, v54
    v_add_f32 v135, v135, v55
    v_cvt_pk_bf16_f32 v78, v132, v133
    v_cvt_pk_bf16_f32 v79, v134, v135
    buffer_store_dwordx2 v[78:79], v7, s[40:43], 0 offen offset:128
    s_branch K3_END
K3_FINAL:
    s_sub_u32 s19, s3, 4
    s_lshl_b32 s37, s19, 4
    s_add_u32 s37, s37, s16
    v_lshlrev_b32 v2, 2, v0
    v_add_u32 v2, s18, v2
    v_lshlrev_b32 v3, 11, v2
    s_lshl_b32 s38, s37, 1
    v_add_u32 v3, s38, v3
    s_mul_i32 s38, s37, 1280
    v_add_u32 v4, s38, v2
    s_mul_i32 s38, s37, 2560
    v_add_u32 v5, s38, v2
    v_mov_b32 v6, 0x7fffffff
    v_cmp_gt_u32 vcc, 40, v0
    s_nop 1
    v_cndmask_b32 v3, v6, v3, vcc
    v_cndmask_b32 v4, v6, v4, vcc
    v_cndmask_b32 v5, v6, v5, vcc
    s_mov_b32 s44, 4096
    s_mov_b32 s45, 0xffff0000
    s_mov_b32 s49, 5120
    s_mov_b32 s50, 10240
    s_mov_b32 s51, 15360
    s_mov_b32 s52, 20480
    s_mov_b32 s53, 25600
    s_mov_b32 s54, 30720
    s_mov_b32 s55, 35840
    s_waitcnt lgkmcnt(0)
    s_add_u32 s28, s4, 0xf00000
    s_addc_u32 s29, s5, 0
    s_mov_b32 s30, 0x280000
    s_mov_b32 s31, 0x20000
    s_mov_b32 s32, s8
    s_mov_b32 s33, s9
    s_mov_b32 s34, 0x280000
    s_mov_b32 s35, 0x20000
    s_mov_b32 s40, s10
    s_mov_b32 s41, s11
    s_mov_b32 s42, 0x500000
    s_mov_b32 s43, 0x20000
    buffer_load_dwordx4 v[16:19], v3, s[28:31], 0 offen
    buffer_load_dwordx4 v[20:23], v3, s[28:31], 0 offen offset:16
    buffer_load_dwordx4 v[24:27], v3, s[28:31], s44 offen
    buffer_load_dwordx4 v[28:31], v3, s[28:31], s44 offen offset:16
    buffer_load_dword v32, v4, s[32:35], 0 offen offset:0
    buffer_load_dword v33, v4, s[32:35], 0 offen offset:1280
    buffer_load_dword v34, v4, s[32:35], 0 offen offset:2560
    buffer_load_dword v35, v4, s[32:35], 0 offen offset:3840
    buffer_load_dword v36, v4, s[32:35], s49 offen offset:0
    buffer_load_dword v37, v4, s[32:35], s49 offen offset:1280
    buffer_load_dword v38, v4, s[32:35], s49 offen offset:2560
    buffer_load_dword v39, v4, s[32:35], s49 offen offset:3840
    buffer_load_dword v40, v4, s[32:35], s50 offen offset:0
    buffer_load_dword v41, v4, s[32:35], s50 offen offset:1280
    buffer_load_dword v42, v4, s[32:35], s50 offen offset:2560
    buffer_load_dword v43, v4, s[32:35], s50 offen offset:3840
    buffer_load_dword v44, v4, s[32:35], s51 offen offset:0
    buffer_load_dword v45, v4, s[32:35], s51 offen offset:1280
    buffer_load_dword v46, v4, s[32:35], s51 offen offset:2560
    buffer_load_dword v47, v4, s[32:35], s51 offen offset:3840
    s_add_u32 s24, s4, 0x1180000
    s_addc_u32 s25, s5, 0
    s_mov_b32 s26, 0xc8000
    s_mov_b32 s27, 0x20000
    v_lshlrev_b32 v12, 4, v0
    s_mul_i32 s37, s19, 25600
    s_mul_i32 s38, s17, 102400
    s_add_u32 s38, s38, s37
    s_barrier
    s_add_u32 m0, s37, 15360
    s_add_u32 s39, s38, 15360
    buffer_load_dwordx4 v12, s[24:27], s39 offen offset:0 lds
    buffer_load_dwordx4 v12, s[24:27], s39 offen offset:1024 lds
    buffer_load_dwordx4 v12, s[24:27], s39 offen offset:2048 lds
    buffer_load_dwordx4 v12, s[24:27], s39 offen offset:3072 lds
    s_add_u32 m0, s37, 19456
    s_add_u32 s39, s38, 19456
    buffer_load_dwordx4 v12, s[24:27], s39 offen offset:0 lds
    buffer_load_dwordx4 v12, s[24:27], s39 offen offset:1024 lds
    buffer_load_dwordx4 v12, s[24:27], s39 offen offset:2048 lds
    buffer_load_dwordx4 v12, s[24:27], s39 offen offset:3072 lds
    s_add_u32 m0, s37, 23552
    s_add_u32 s39, s38, 23552
    buffer_load_dwordx4 v12, s[24:27], s39 offen offset:0 lds
    buffer_load_dwordx4 v12, s[24:27], s39 offen offset:1024 lds
    s_waitcnt vmcnt(0)
    s_barrier
    v_lshlrev_b32 v8, 16, v16
    v_lshlrev_b32 v9, 16, v24
    v_lshlrev_b32 v10, 16, v32
    v_and_b32 v11, s45, v32
    v_mul_f32 v8, v8, v10
    v_mul_f32 v9, v9, v11
    v_cvt_pk_bf16_f32 v32, v8, v9
    buffer_store_dword v32, v5, s[40:43], 0 offen offset:0
    v_lshlrev_b32 v8, 16, v18
    v_lshlrev_b32 v9, 16, v26
    v_lshlrev_b32 v10, 16, v33
    v_and_b32 v11, s45, v33
    v_mul_f32 v8, v8, v10
    v_mul_f32 v9, v9, v11
    v_cvt_pk_bf16_f32 v33, v8, v9
    buffer_store_dword v33, v5, s[40:43], 0 offen offset:2560
    v_and_b32 v8, s45, v16
    v_and_b32 v9, s45, v24
    v_lshlrev_b32 v10, 16, v34
    v_and_b32 v11, s45, v34
    v_mul_f32 v8, v8, v10
    v_mul_f32 v9, v9, v11
    v_cvt_pk_bf16_f32 v34, v8, v9
    buffer_store_dword v34, v5, s[40:43], s49 offen offset:0
    v_and_b32 v8, s45, v18
    v_and_b32 v9, s45, v26
    v_lshlrev_b32 v10, 16, v35
    v_and_b32 v11, s45, v35
    v_mul_f32 v8, v8, v10
    v_mul_f32 v9, v9, v11
    v_cvt_pk_bf16_f32 v35, v8, v9
    buffer_store_dword v35, v5, s[40:43], s49 offen offset:2560
    v_lshlrev_b32 v8, 16, v17
    v_lshlrev_b32 v9, 16, v25
    v_lshlrev_b32 v10, 16, v36
    v_and_b32 v11, s45, v36
    v_mul_f32 v8, v8, v10
    v_mul_f32 v9, v9, v11
    v_cvt_pk_bf16_f32 v36, v8, v9
    buffer_store_dword v36, v5, s[40:43], s50 offen offset:0
    v_lshlrev_b32 v8, 16, v19
    v_lshlrev_b32 v9, 16, v27
    v_lshlrev_b32 v10, 16, v37
    v_and_b32 v11, s45, v37
    v_mul_f32 v8, v8, v10
    v_mul_f32 v9, v9, v11
    v_cvt_pk_bf16_f32 v37, v8, v9
    buffer_store_dword v37, v5, s[40:43], s50 offen offset:2560
    v_and_b32 v8, s45, v17
    v_and_b32 v9, s45, v25
    v_lshlrev_b32 v10, 16, v38
    v_and_b32 v11, s45, v38
    v_mul_f32 v8, v8, v10
    v_mul_f32 v9, v9, v11
    v_cvt_pk_bf16_f32 v38, v8, v9
    buffer_store_dword v38, v5, s[40:43], s51 offen offset:0
    v_and_b32 v8, s45, v19
    v_and_b32 v9, s45, v27
    v_lshlrev_b32 v10, 16, v39
    v_and_b32 v11, s45, v39
    v_mul_f32 v8, v8, v10
    v_mul_f32 v9, v9, v11
    v_cvt_pk_bf16_f32 v39, v8, v9
    buffer_store_dword v39, v5, s[40:43], s51 offen offset:2560
    v_lshlrev_b32 v8, 16, v20
    v_lshlrev_b32 v9, 16, v28
    v_lshlrev_b32 v10, 16, v40
    v_and_b32 v11, s45, v40
    v_mul_f32 v8, v8, v10
    v_mul_f32 v9, v9, v11
    v_cvt_pk_bf16_f32 v40, v8, v9
    buffer_store_dword v40, v5, s[40:43], s52 offen offset:0
    v_lshlrev_b32 v8, 16, v22
    v_lshlrev_b32 v9, 16, v30
    v_lshlrev_b32 v10, 16, v41
    v_and_b32 v11, s45, v41
    v_mul_f32 v8, v8, v10
    v_mul_f32 v9, v9, v11
    v_cvt_pk_bf16_f32 v41, v8, v9
    buffer_store_dword v41, v5, s[40:43], s52 offen offset:2560
    v_and_b32 v8, s45, v20
    v_and_b32 v9, s45, v28
    v_lshlrev_b32 v10, 16, v42
    v_and_b32 v11, s45, v42
    v_mul_f32 v8, v8, v10
    v_mul_f32 v9, v9, v11
    v_cvt_pk_bf16_f32 v42, v8, v9
    buffer_store_dword v42, v5, s[40:43], s53 offen offset:0
    v_and_b32 v8, s45, v22
    v_and_b32 v9, s45, v30
    v_lshlrev_b32 v10, 16, v43
    v_and_b32 v11, s45, v43
    v_mul_f32 v8, v8, v10
    v_mul_f32 v9, v9, v11
    v_cvt_pk_bf16_f32 v43, v8, v9
    buffer_store_dword v43, v5, s[40:43], s53 offen offset:2560
    v_lshlrev_b32 v8, 16, v21
    v_lshlrev_b32 v9, 16, v29
    v_lshlrev_b32 v10, 16, v44
    v_and_b32 v11, s45, v44
    v_mul_f32 v8, v8, v10
    v_mul_f32 v9, v9, v11
    v_cvt_pk_bf16_f32 v44, v8, v9
    buffer_store_dword v44, v5, s[40:43], s54 offen offset:0
    v_lshlrev_b32 v8, 16, v23
    v_lshlrev_b32 v9, 16, v31
    v_lshlrev_b32 v10, 16, v45
    v_and_b32 v11, s45, v45
    v_mul_f32 v8, v8, v10
    v_mul_f32 v9, v9, v11
    v_cvt_pk_bf16_f32 v45, v8, v9
    buffer_store_dword v45, v5, s[40:43], s54 offen offset:2560
    v_and_b32 v8, s45, v21
    v_and_b32 v9, s45, v29
    v_lshlrev_b32 v10, 16, v46
    v_and_b32 v11, s45, v46
    v_mul_f32 v8, v8, v10
    v_mul_f32 v9, v9, v11
    v_cvt_pk_bf16_f32 v46, v8, v9
    buffer_store_dword v46, v5, s[40:43], s55 offen offset:0
    v_and_b32 v8, s45, v23
    v_and_b32 v9, s45, v31
    v_lshlrev_b32 v10, 16, v47
    v_and_b32 v11, s45, v47
    v_mul_f32 v8, v8, v10
    v_mul_f32 v9, v9, v11
    v_cvt_pk_bf16_f32 v47, v8, v9
    buffer_store_dword v47, v5, s[40:43], s55 offen offset:2560
    s_branch K3_EXIT
K3_END:
K3_EXIT:
    s_endpgm
    s_nop 0
    s_nop 0
    s_nop 0
    s_nop 0
K_TEXT_END:
.section .rodata,"a"
.p2align 6
.amdhsa_kernel k1_kernel
  .amdhsa_next_free_vgpr 168
  .amdhsa_next_free_sgpr 102
  .amdhsa_accum_offset 168
  .amdhsa_group_segment_fixed_size 0
  .amdhsa_kernarg_size 96
  .amdhsa_user_sgpr_count 2
  .amdhsa_user_sgpr_kernarg_segment_ptr 1
  .amdhsa_system_sgpr_workgroup_id_x 1
.end_amdhsa_kernel
.p2align 6
.amdhsa_kernel k2_kernel
  .amdhsa_next_free_vgpr 128
  .amdhsa_next_free_sgpr 102
  .amdhsa_accum_offset 128
  .amdhsa_group_segment_fixed_size 0
  .amdhsa_kernarg_size 96
  .amdhsa_user_sgpr_count 2
  .amdhsa_user_sgpr_kernarg_segment_ptr 1
  .amdhsa_system_sgpr_workgroup_id_x 1
.end_amdhsa_kernel
.p2align 6
.amdhsa_kernel k3_kernel
  .amdhsa_next_free_vgpr 224
  .amdhsa_next_free_sgpr 102
  .amdhsa_accum_offset 224
  .amdhsa_group_segment_fixed_size 0
  .amdhsa_kernarg_size 96
  .amdhsa_user_sgpr_count 2
  .amdhsa_user_sgpr_kernarg_segment_ptr 1
  .amdhsa_system_sgpr_workgroup_id_x 1
.end_amdhsa_kernel
```
